```python
import torch

def _softmax(x, axis=-1):
    return torch.softmax(x, dim=axis)
def _gelu(x):
    return torch.nn.functional.gelu(x, approximate="tanh")
def _silu(x):
    return torch.nn.functional.silu(x)
def _sigmoid(x):
    return torch.sigmoid(x)
def _layernorm(x, axis=-1, eps=1e-5):
    m = x.mean(dim=axis, keepdim=True)
    v = x.var(dim=axis, keepdim=True, unbiased=False)
    return (x - m) / torch.sqrt(v + eps)
def _scatter_add(tgt, idx, src, axis=0):
    return tgt.clone().index_add_(axis, idx, src)
def _segment_sum(src, seg, n):
    out = torch.zeros((n,) + src.shape[1:], dtype=src.dtype)
    return out.index_add_(0, seg, src)
def _pad(x, pw):
    flat = tuple(v for pair in reversed(pw) for v in pair)
    return torch.nn.functional.pad(x, flat)

kernel_name = 'parallel_sum__ssm_conv_s5__dense_activation_squared_relu__prompt'

def setup_inputs():

    _w = (lambda a: (lambda t: t.to(torch.bfloat16) if t.is_floating_point() else t)(torch.as_tensor(a)))
    def _A_setup():
        B, S, D = 1, 2048, 512
        P = D
        Lambda_re = -0.5 * (lambda _x: torch.exp(torch.as_tensor(_x)))((lambda *s: torch.randn(*s, dtype=torch.bfloat16) * 0.8)(P))
        Lambda_im = (lambda *s: torch.randn(*s, dtype=torch.bfloat16) * 0.8)(P) * 1.0
        B_re = (lambda *s: torch.randn(*s, dtype=torch.bfloat16) * 0.8)(P, D) * (D ** -0.5)
        B_im = (lambda *s: torch.randn(*s, dtype=torch.bfloat16) * 0.8)(P, D) * (D ** -0.5)
        C_re = (lambda *s: torch.randn(*s, dtype=torch.bfloat16) * 0.8)(D, P) * (P ** -0.5)
        C_im = (lambda *s: torch.randn(*s, dtype=torch.bfloat16) * 0.8)(D, P) * (P ** -0.5)
        log_dt = (lambda *s: torch.randn(*s, dtype=torch.bfloat16) * 0.8)(P) * 0.3 - 2.0
        Dskip = (lambda *s: torch.randn(*s, dtype=torch.bfloat16) * 0.4)(D)
        return {
            "x": _w((lambda *s: torch.randn(*s, dtype=torch.bfloat16) * 0.05)(B, S, D)),
            "Lambda_re": _w(Lambda_re),
            "Lambda_im": _w(Lambda_im),
            "B_re": _w(B_re),
            "B_im": _w(B_im),
            "C_re": _w(C_re),
            "C_im": _w(C_im),
            "log_dt": _w(log_dt),
            "Dskip": _w(Dskip),
        }
    _A_in = _A_setup()

    def _B_setup():
        B, S, D, F = 1, 2048, 512, 1376
        return {
            "x": _w((lambda *s: torch.randn(*s, dtype=torch.bfloat16) * 0.05)(B, S, D)),
            "w1": _w((lambda *s: torch.randn(*s, dtype=torch.bfloat16) * 0.05)(D, F)),
            "b1": _w((lambda *s: torch.randn(*s, dtype=torch.bfloat16) * 0.2)(F)),
            "w2": _w((lambda *s: torch.randn(*s, dtype=torch.bfloat16) * 0.05)(F, D)),
            "b2": _w((lambda *s: torch.randn(*s, dtype=torch.bfloat16) * 0.8)(D)),
        }
    _B_in = _B_setup()

    return {
        "A_x": _A_in["x"],
        "A_Lambda_re": _A_in["Lambda_re"],
        "A_Lambda_im": _A_in["Lambda_im"],
        "A_B_re": _A_in["B_re"],
        "A_B_im": _A_in["B_im"],
        "A_C_re": _A_in["C_re"],
        "A_C_im": _A_in["C_im"],
        "A_log_dt": _A_in["log_dt"],
        "A_Dskip": _A_in["Dskip"],
        "B_x": _B_in["x"],
        "B_w1": _B_in["w1"],
        "B_b1": _B_in["b1"],
        "B_w2": _B_in["w2"],
        "B_b2": _B_in["b2"],
    }

def reference(A_x, A_Lambda_re, A_Lambda_im, A_B_re, A_B_im, A_C_re, A_C_im, A_log_dt, A_Dskip, B_x, B_w1, B_b1, B_w2, B_b2):
    def _A_ref(x, Lambda_re, Lambda_im, B_re, B_im, C_re, C_im, log_dt, Dskip):
        Bsz, L, H = x.shape
        Lam = Lambda_re + 1j * Lambda_im
        Bmat = B_re + 1j * B_im
        Cmat = C_re + 1j * C_im
        dt = torch.exp(log_dt)
        Lam_bar = torch.exp(dt * Lam)
        B_bar = ((Lam_bar - 1.0) / Lam)[:, None] * Bmat
        Bu = torch.einsum("bld,pd->blp", x + 0j, B_bar)
        h = torch.zeros_like(Bu[:, 0, :])
        hs = []
        for t in range(L):
            h = Lam_bar[None, :] * h + Bu[:, t, :]
            hs.append(h)
        hseq = torch.stack(hs, 1)
        y = 2.0 * torch.einsum("blp,dp->bld", hseq, Cmat).real + x * Dskip[None, None, :]
        return y

    def _B_ref(x, w1, b1, w2, b2):
        h = torch.einsum("bsd,df->bsf", x, w1) + b1
        zero = torch.zeros_like(h)
        r = torch.where(h > zero, h, zero)
        h = r * r
        out = torch.einsum("bsf,fd->bsd", h, w2) + b2
        return out

    x = A_x
    xn = _layernorm(x, axis=-1)
    return x + _A_ref(xn, A_Lambda_re, A_Lambda_im, A_B_re, A_B_im, A_C_re, A_C_im, A_log_dt, A_Dskip) + _B_ref(xn, B_w1, B_b1, B_w2, B_b2)
```

```asm
; @launch grid=(256,1,1) block=(256,1,1) lds=163840
.amdgcn_target "amdgcn-amd-amdhsa--gfx950"
.text
.globl parallel_sum__ssm_conv_s5__dense_activation_squared_relu__prompt_kernel
.p2align 8
.type parallel_sum__ssm_conv_s5__dense_activation_squared_relu__prompt_kernel,@function
parallel_sum__ssm_conv_s5__dense_activation_squared_relu__prompt_kernel:
    s_cmp_ge_u32 s2, 256
    s_cbranch_scc1 L_end
    s_load_dwordx16 s[4:19], s[0:1], 0
    s_load_dwordx16 s[20:35], s[0:1], 64
    s_load_dwordx2 s[36:37], s[0:1], 128
    v_lshrrev_b32 v1, 6, v0
    v_and_b32 v0, 63, v0
    v_readfirstlane_b32 s3, v1
    s_getpc_b64 s[90:91]
L_pc:
    s_lshr_b32 s81, s2, 3
    s_lshl_b32 s81, s81, 2
    s_add_u32 s81, s81, s3
    s_lshl_b32 s81, s81, 8
    v_lshl_add_u32 v6, v0, 7, s81
    v_min_u32 v2, L_code_end-L_pc-128, v6
    s_mov_b64 exec, 3
    global_load_dword v5, v2, s[90:91]
    s_mov_b64 exec, -1
    s_and_b32 s38, s2, 7
    s_lshl_b32 s38, s38, 1
    s_bfe_u32 s39, s2, 0x10003
    s_add_u32 s38, s38, s39
    s_lshr_b32 s39, s2, 4
    s_and_b32 s74, s39, 7
    s_lshl_b32 s78, s3, 12
    s_lshl_b32 s79, s3, 11
    v_and_b32 v7, 31, v0
    v_lshrrev_b32 v8, 5, v0
    v_lshrrev_b32 v9, 3, v0
    v_lshrrev_b32 v10, 4, v0
    v_and_b32 v11, 7, v0
    s_lshl_b32 s81, s38, 7
    s_lshl_b32 s82, s39, 3
    s_add_u32 s82, s81, s82
    s_lshl_b32 s83, s3, 1
    s_add_u32 s82, s82, s83
    v_add_u32 v29, s82, v8
    v_lshlrev_b32 v2, 4, v7
    v_lshl_add_u32 v28, v29, 10, v2
    v_xor_b32 v30, v11, v10
    v_lshlrev_b32 v30, 4, v30
    v_xor_b32 v31, 64, v30
    s_lshl_b32 s82, s3, 5
    s_add_u32 s81, s81, s82
    v_and_b32 v1, 3, v9
    v_lshl_add_u32 v1, v8, 4, v1
    v_add_u32 v1, s81, v1
    v_lshlrev_b32 v1, 10, v1
    v_add_u32 v32, v1, v30
    v_add_u32 v2, v1, v31
    v_add_u32 v33, 3072, v2
    v_add_u32 v34, 6144, v32
    v_add_u32 v35, 9216, v2
    s_lshl_b32 s81, s39, 5
    s_and_b32 s82, s3, 1
    s_lshl_b32 s82, s82, 4
    s_add_u32 s81, s81, s82
    v_add_u32 v1, s81, v9
    v_lshlrev_b32 v1, 10, v1
    v_add_u32 v36, v1, v30
    v_add_u32 v2, v1, v31
    v_add_u32 v37, 7168, v2
    s_waitcnt lgkmcnt(0)
    s_mov_b32 s40, s4
    s_mov_b32 s41, s5
    s_mov_b32 s42, 2097152
    s_mov_b32 s43, 0x20000
    s_load_dword s72, s[36:37], 0
    s_cmp_lt_u32 s3, 2
    s_cselect_b32 s44, s10, s12
    s_cselect_b32 s45, s11, s13
    s_mov_b32 s46, 0x80000
    s_mov_b32 s47, 0x20000
    buffer_load_dwordx4 v[38:41], v28, s[40:43], 0 offen
    buffer_load_dwordx4 v[42:45], v28, s[40:43], 0 offen offset:512
    s_add_u32 m0, s78, 0
    s_movk_i32 s81, 0
    buffer_load_dwordx4 v32, s[40:43], s81 offen offset:0  lds
    buffer_load_dwordx4 v33, s[40:43], s81 offen offset:1024  lds
    buffer_load_dwordx4 v34, s[40:43], s81 offen offset:2048  lds
    buffer_load_dwordx4 v35, s[40:43], s81 offen offset:3072  lds
    s_add_u32 m0, s79, 65536
    s_nop 0
    buffer_load_dwordx4 v36, s[44:47], s81 offen offset:0 lds
    buffer_load_dwordx4 v37, s[44:47], s81 offen offset:1024 lds
    s_mul_i32 s77, s39, 3
    s_lshl_b32 s81, s39, 1
    s_add_u32 s81, s81, 11
    s_min_u32 s77, s77, s81
    s_lshl_b32 s81, s39, 6
    v_lshl_add_u32 v46, v7, 1, s81
    s_lshl_b32 s81, s77, 6
    v_lshl_add_u32 v47, v7, 1, s81
    s_lshl_b32 s81, s74, 7
    v_and_b32 v1, 15, v0
    v_lshl_add_u32 v48, v1, 3, s81
    s_lshr_b32 s75, s39, 3
    s_lshl_b32 s76, s38, 1
    s_add_u32 s75, s75, s76
    s_lshr_b32 s82, s3, 1
    s_add_u32 s76, s76, s82
    s_mul_i32 s80, s3, 3072
    s_lshl_b32 s81, s2, 1
    s_and_b32 s82, s3, 1
    s_add_u32 s81, s81, s82
    s_lshl_b32 s81, s81, 10
    v_lshl_add_u32 v51, v0, 7, s81
    s_lshl_b32 s81, s2, 2
    s_add_u32 s81, s81, s3
    s_mul_i32 s81, s81, 1376
    v_lshl_add_u32 v52, v0, 7, s81
    s_mov_b32 s48, s24
    s_mov_b32 s49, s25
    s_mov_b32 s50, 1409024
    s_mov_b32 s51, 0x20000
    s_mov_b32 s64, s36
    s_mov_b32 s65, s37
    s_mov_b32 s66, 16777216
    s_mov_b32 s67, 0x20000
    s_mov_b32 s68, s32
    s_mov_b32 s69, s33
    s_mov_b32 s70, 4194304
    s_mov_b32 s71, 0x20000
    s_mov_b64 exec, 254
    buffer_load_dword v5, v51, s[44:47], 0 offen
    s_mov_b64 exec, -1
    s_mov_b64 exec, 2047
    buffer_load_dword v5, v52, s[48:51], 0 offen
    s_mov_b64 exec, -1
    global_load_ushort v53, v46, s[6:7]
    global_load_ushort v54, v46, s[8:9]
    global_load_ushort v55, v46, s[18:19]
    s_mov_b32 s52, s14
    s_mov_b32 s53, s15
    s_mov_b32 s54, 524288
    s_mov_b32 s55, 0x20000
    s_mov_b32 s56, s16
    s_mov_b32 s57, s17
    s_mov_b32 s58, 524288
    s_mov_b32 s59, 0x20000
    s_mov_b32 s60, s28
    s_mov_b32 s61, s29
    s_mov_b32 s62, 1409024
    s_mov_b32 s63, 0x20000
    s_cmp_lt_u32 s3, 2
    s_cselect_b32 s8, s14, s16
    s_cselect_b32 s9, s15, s17
    s_mov_b32 s10, 0x80000
    s_mov_b32 s11, 0x20000
    v_lshrrev_b32 v29, 1, v29
    v_lshlrev_b32 v29, 7, v29
    v_lshl_add_u32 v29, v8, 3, v29
    v_add_u32 v29, 262144, v29
    v_bfe_u32 v3, v7, 1, 3
    v_lshlrev_b32 v4, 7, v7
    s_add_u32 s82, s3, 0
    s_and_b32 s82, s82, 3
    s_lshl_b32 s82, s82, 1
    v_add_u32 v1, s82, v8
    v_xor_b32 v1, v1, v3
    v_lshl_add_u32 v1, v1, 4, v4
    v_add_u32 v59, s78, v1
    v_add_u32 v63, 65536, v1
    s_add_u32 s82, s3, 1
    s_and_b32 s82, s82, 3
    s_lshl_b32 s82, s82, 1
    v_add_u32 v1, s82, v8
    v_xor_b32 v1, v1, v3
    v_lshl_add_u32 v1, v1, 4, v4
    v_add_u32 v60, s78, v1
    v_add_u32 v64, 65536, v1
    s_add_u32 s82, s3, 2
    s_and_b32 s82, s82, 3
    s_lshl_b32 s82, s82, 1
    v_add_u32 v1, s82, v8
    v_xor_b32 v1, v1, v3
    v_lshl_add_u32 v1, v1, 4, v4
    v_add_u32 v61, s78, v1
    v_add_u32 v65, 65536, v1
    s_add_u32 s82, s3, 3
    s_and_b32 s82, s82, 3
    s_lshl_b32 s82, s82, 1
    v_add_u32 v1, s82, v8
    v_xor_b32 v1, v1, v3
    v_lshl_add_u32 v1, v1, 4, v4
    v_add_u32 v62, s78, v1
    v_add_u32 v66, 65536, v1
    v_mov_b32 v1, 0x3f803f80
    v_cmp_eq_u32 vcc, 0, v7
    s_nop 1
    v_cndmask_b32 v244, 0, v1, vcc
    v_mov_b32 v245, v244
    v_mov_b32 v246, v244
    v_mov_b32 v247, v244
    v_cmp_eq_u32 vcc, 1, v7
    s_nop 1
    v_cndmask_b32 v248, 0, v1, vcc
    v_mov_b32 v249, v248
    v_mov_b32 v250, v248
    v_mov_b32 v251, v248
    v_cmp_eq_u32 vcc, 2, v7
    s_nop 1
    v_cndmask_b32 v252, 0, v1, vcc
    v_mov_b32 v253, v252
    v_mov_b32 v254, v252
    v_mov_b32 v255, v252
    s_mul_i32 s82, s3, 192
    s_lshl_b32 s83, s77, 6
    s_mov_b32 s88, 0x15555556
    s_movk_i32 s89, 2752
    s_cmp_lt_u32 s39, 11
    s_cselect_b32 s19, -1, 127
    v_add_u32 v1, s82, v0
    v_add_u32 v1, 0, v1
    v_mul_hi_u32 v2, v1, s88
    v_mul_u32_u24 v3, 12, v2
    v_sub_u32 v3, v1, v3
    v_lshlrev_b32 v3, 4, v3
    v_mul_lo_u32 v2, v2, s89
    v_add3_u32 v67, v2, v3, s83
    v_cmp_lt_u32 vcc, s19, v3
    v_mov_b32 v1, 1073741824
    s_nop 0
    v_cndmask_b32 v67, v67, v1, vcc
    v_add_u32 v1, s82, v0
    v_add_u32 v1, 64, v1
    v_mul_hi_u32 v2, v1, s88
    v_mul_u32_u24 v3, 12, v2
    v_sub_u32 v3, v1, v3
    v_lshlrev_b32 v3, 4, v3
    v_mul_lo_u32 v2, v2, s89
    v_add3_u32 v68, v2, v3, s83
    v_subrev_u32 v68, 1024, v68
    v_cmp_lt_u32 vcc, s19, v3
    v_mov_b32 v1, 1073741824
    s_nop 0
    v_cndmask_b32 v68, v68, v1, vcc
    v_add_u32 v1, s82, v0
    v_add_u32 v1, 128, v1
    v_mul_hi_u32 v2, v1, s88
    v_mul_u32_u24 v3, 12, v2
    v_sub_u32 v3, v1, v3
    v_lshlrev_b32 v3, 4, v3
    v_mul_lo_u32 v2, v2, s89
    v_add3_u32 v69, v2, v3, s83
    v_subrev_u32 v69, 2048, v69
    v_cmp_lt_u32 vcc, s19, v3
    v_mov_b32 v1, 1073741824
    s_nop 0
    v_cndmask_b32 v69, v69, v1, vcc
    v_bfe_u32 v1, v7, 2, 1
    v_lshlrev_b32 v1, 4, v1
    v_lshrrev_b32 v2, 3, v7
    v_lshl_add_u32 v1, v2, 2, v1
    v_and_b32 v2, 3, v7
    v_add_u32 v1, v1, v2
    s_lshl_b32 s82, s3, 5
    v_add_u32 v49, s82, v1
    s_lshl_b32 s82, s38, 13
    s_add_u32 s82, s82, 262144
    v_lshrrev_b32 v2, 1, v49
    v_lshl_add_u32 v50, v2, 7, s82
    v_and_b32 v2, 1, v49
    v_lshl_add_u32 v50, v2, 3, v50
    v_lshlrev_b32 v49, 2, v49
    v_add_u32 v49, 159744, v49
    v_bfe_u32 v22, v0, 2, 2
    v_and_b32 v23, 3, v0
    v_lshl_add_u32 v1, v8, 3, v22
    v_mul_u32_u24 v1, 192, v1
    v_and_b32 v2, 1, v10
    v_lshl_add_u32 v1, v2, 5, v1
    v_lshl_add_u32 v1, v23, 3, v1
    s_add_u32 s82, s3, 0
    s_and_b32 s82, s82, 3
    s_mul_i32 s82, s82, 3072
    s_add_u32 s82, s82, 98304
    v_add_u32 v70, s82, v1
    s_add_u32 s82, s3, 1
    s_and_b32 s82, s82, 3
    s_mul_i32 s82, s82, 3072
    s_add_u32 s82, s82, 98304
    v_add_u32 v71, s82, v1
    s_add_u32 s82, s3, 2
    s_and_b32 s82, s82, 3
    s_mul_i32 s82, s82, 3072
    s_add_u32 s82, s82, 98304
    v_add_u32 v72, s82, v1
    s_add_u32 s82, s3, 3
    s_and_b32 s82, s82, 3
    s_mul_i32 s82, s82, 3072
    s_add_u32 s82, s82, 98304
    v_add_u32 v73, s82, v1
    s_lshl_b32 s82, s75, 6
    s_lshl_b32 s83, s3, 4
    s_add_u32 s82, s82, s83
    v_add_u32 v1, s82, v9
    v_lshlrev_b32 v1, 10, v1
    v_lshl_add_u32 v1, v11, 4, v1
    s_lshl_b32 s82, s74, 7
    v_add_u32 v80, s82, v1
    v_add_u32 v81, 7168, v80
    s_lshl_b32 s82, s74, 6
    v_add_u32 v1, s82, v9
    v_lshlrev_b32 v1, 10, v1
    s_lshl_b32 s82, s3, 8
    v_add_u32 v1, s82, v1
    v_add_u32 v12, v1, v30
    v_add_u32 v2, v1, v31
    v_add_u32 v13, 7168, v2
    v_add_u32 v14, 14336, v12
    v_add_u32 v15, 21504, v2
    s_mul_i32 s82, s3, 352
    v_add_u32 v1, s82, v9
    v_lshlrev_b32 v1, 10, v1
    v_lshlrev_b32 v2, 1, v10
    v_xor_b32 v2, v11, v2
    v_lshl_add_u32 v1, v2, 4, v1
    s_lshl_b32 s82, s74, 7
    v_add_u32 v76, s82, v1
    v_add_u32 v77, 7168, v76
    v_add_u32 v78, 14336, v76
    v_add_u32 v79, 21504, v76
    s_lshl_b32 s82, s3, 2
    v_lshl_add_u32 v82, v7, 4, s82
    v_and_b32 v1, 15, v0
    v_lshrrev_b32 v2, 1, v1
    v_xor_b32 v2, v2, v10
    v_lshlrev_b32 v1, 7, v1
    s_add_u32 s82, s78, 49152
    v_add_u32 v1, s82, v1
    v_lshl_add_u32 v20, v2, 4, v1
    v_xor_b32 v21, 64, v20
    s_add_u32 s82, s78, 98304
    v_and_b32 v1, 1, v10
    v_lshrrev_b32 v2, 1, v22
    v_lshl_add_u32 v2, v1, 1, v2
    v_lshl_add_u32 v1, v1, 2, v22
    v_lshl_add_u32 v1, v8, 4, v1
    v_lshlrev_b32 v1, 7, v1
    v_lshl_add_u32 v1, v23, 3, v1
    v_add_u32 v1, s82, v1
    v_xor_b32 v3, 0, v2
    v_lshl_add_u32 v16, v3, 5, v1
    v_xor_b32 v3, 1, v2
    v_lshl_add_u32 v17, v3, 5, v1
    v_xor_b32 v3, 2, v2
    v_lshl_add_u32 v18, v3, 5, v1
    v_xor_b32 v3, 3, v2
    v_lshl_add_u32 v19, v3, 5, v1
    s_mul_i32 s82, s3, 2560
    s_add_u32 s82, s82, 147456
    v_mul_u32_u24 v83, 80, v7
    v_lshl_add_u32 v83, v8, 5, v83
    v_add_u32 v83, s82, v83
    v_lshl_add_u32 v1, v10, 3, v22
    v_mul_u32_u24 v84, 80, v1
    v_and_b32 v1, 1, v23
    v_lshl_add_u32 v84, v1, 5, v84
    v_lshrrev_b32 v1, 1, v23
    v_lshl_add_u32 v84, v1, 3, v84
    v_add_u32 v84, s82, v84
    s_lshl_b32 s82, s76, 4
    s_add_u32 s82, s82, s39
    s_lshl_b32 s82, s82, 1
    s_and_b32 s83, s3, 1
    s_lshl_b32 s19, s38, 4
    s_add_u32 s19, s19, s39
    s_lshl_b32 s19, s19, 7
    s_add_u32 s19, s19, 196608
    s_cmp_eq_u32 s3, 0
    s_cselect_b32 s19, s19, 1073741824
    v_mov_b32 v86, s19
    s_lshl_b32 s82, s82, 12
    s_lshl_b32 s83, s83, 11
    s_add_u32 s82, s82, s83
    s_add_u32 s82, s82, 8388608
    v_lshl_add_u32 v85, v0, 4, s82
    s_mul_i32 s82, s76, 43
    s_add_u32 s82, s82, s77
    s_lshl_b32 s82, s82, 12
    s_add_u32 s82, s82, s83
    s_add_u32 s82, s82, 1048576
    v_lshrrev_b32 v2, 4, v7
    v_lshl_add_u32 v88, v2, 10, s82
    v_lshl_add_u32 v88, v8, 8, v88
    v_and_b32 v2, 15, v0
    v_lshl_add_u32 v88, v2, 4, v88
    s_lshl_b32 s82, s3, 9
    v_lshlrev_b32 v90, 4, v7
    v_add_u32 v90, 147456, v90
    v_lshl_add_u32 v89, v8, 3, v90
    v_add_u32 v89, s82, v89
    s_mov_b32 s19, 1073741824
    s_movk_i32 s16, 4096
    s_cmp_lt_u32 s39, 11
    s_cselect_b32 s17, 8192, 1073741824
    s_waitcnt vmcnt(11)
    v_lshlrev_b32 v228, 16, v38
    v_and_b32 v229, 0xffff0000, v38
    v_lshlrev_b32 v230, 16, v39
    v_and_b32 v231, 0xffff0000, v39
    v_lshlrev_b32 v232, 16, v40
    v_and_b32 v233, 0xffff0000, v40
    v_lshlrev_b32 v234, 16, v41
    v_and_b32 v235, 0xffff0000, v41
    v_lshlrev_b32 v236, 16, v42
    v_and_b32 v237, 0xffff0000, v42
    v_lshlrev_b32 v238, 16, v43
    v_and_b32 v239, 0xffff0000, v43
    v_lshlrev_b32 v240, 16, v44
    v_and_b32 v241, 0xffff0000, v44
    v_lshlrev_b32 v242, 16, v45
    v_and_b32 v243, 0xffff0000, v45
    v_pk_add_f32 v[22:23], v[228:229], v[230:231]
    v_pk_add_f32 v[22:23], v[22:23], v[232:233]
    v_pk_add_f32 v[22:23], v[22:23], v[234:235]
    v_pk_add_f32 v[22:23], v[22:23], v[236:237]
    v_pk_add_f32 v[22:23], v[22:23], v[238:239]
    v_pk_add_f32 v[22:23], v[22:23], v[240:241]
    v_pk_add_f32 v[22:23], v[22:23], v[242:243]
    v_add_f32 v22, v22, v23
    s_nop 1
    v_add_f32_dpp v22, v22, v22 row_ror:8 row_mask:0xf bank_mask:0xf
    s_nop 1
    v_add_f32_dpp v22, v22, v22 row_ror:4 row_mask:0xf bank_mask:0xf
    s_nop 1
    v_add_f32_dpp v22, v22, v22 row_ror:2 row_mask:0xf bank_mask:0xf
    s_nop 1
    v_add_f32_dpp v22, v22, v22 row_ror:1 row_mask:0xf bank_mask:0xf
    v_mov_b32 v23, v22
    s_nop 1
    v_permlane16_swap_b32 v22, v23
    v_add_f32 v22, v22, v23
    v_mul_f32 v30, 0x3b000000, v22
    v_pk_add_f32 v[228:229], v[228:229], v[30:31] op_sel_hi:[1,0] neg_lo:[0,1] neg_hi:[0,1]
    v_pk_add_f32 v[230:231], v[230:231], v[30:31] op_sel_hi:[1,0] neg_lo:[0,1] neg_hi:[0,1]
    v_pk_add_f32 v[232:233], v[232:233], v[30:31] op_sel_hi:[1,0] neg_lo:[0,1] neg_hi:[0,1]
    v_pk_add_f32 v[234:235], v[234:235], v[30:31] op_sel_hi:[1,0] neg_lo:[0,1] neg_hi:[0,1]
    v_pk_add_f32 v[236:237], v[236:237], v[30:31] op_sel_hi:[1,0] neg_lo:[0,1] neg_hi:[0,1]
    v_pk_add_f32 v[238:239], v[238:239], v[30:31] op_sel_hi:[1,0] neg_lo:[0,1] neg_hi:[0,1]
    v_pk_add_f32 v[240:241], v[240:241], v[30:31] op_sel_hi:[1,0] neg_lo:[0,1] neg_hi:[0,1]
    v_pk_add_f32 v[242:243], v[242:243], v[30:31] op_sel_hi:[1,0] neg_lo:[0,1] neg_hi:[0,1]
    v_pk_mul_f32 v[22:23], v[228:229], v[228:229]
    v_pk_fma_f32 v[22:23], v[230:231], v[230:231], v[22:23]
    v_pk_fma_f32 v[22:23], v[232:233], v[232:233], v[22:23]
    v_pk_fma_f32 v[22:23], v[234:235], v[234:235], v[22:23]
    v_pk_fma_f32 v[22:23], v[236:237], v[236:237], v[22:23]
    v_pk_fma_f32 v[22:23], v[238:239], v[238:239], v[22:23]
    v_pk_fma_f32 v[22:23], v[240:241], v[240:241], v[22:23]
    v_pk_fma_f32 v[22:23], v[242:243], v[242:243], v[22:23]
    v_add_f32 v22, v22, v23
    s_nop 1
    v_add_f32_dpp v22, v22, v22 row_ror:8 row_mask:0xf bank_mask:0xf
    s_nop 1
    v_add_f32_dpp v22, v22, v22 row_ror:4 row_mask:0xf bank_mask:0xf
    s_nop 1
    v_add_f32_dpp v22, v22, v22 row_ror:2 row_mask:0xf bank_mask:0xf
    s_nop 1
    v_add_f32_dpp v22, v22, v22 row_ror:1 row_mask:0xf bank_mask:0xf
    v_mov_b32 v23, v22
    s_nop 1
    v_permlane16_swap_b32 v22, v23
    v_add_f32 v22, v22, v23
    v_mul_f32 v22, 0x3b000000, v22
    v_cvt_pk_bf16_f32 v22, v22, v22
    v_lshlrev_b32 v22, 16, v22
    v_add_f32 v22, 0x3727c5ac, v22
    v_cvt_pk_bf16_f32 v22, v22, v22
    v_lshlrev_b32 v22, 16, v22
    v_sqrt_f32 v22, v22
    s_nop 0
    v_cvt_pk_bf16_f32 v22, v30, v22
    s_waitcnt lgkmcnt(0)
    s_mul_i32 s72, s72, 0x9e3779b1
    s_add_u32 s72, s72, 0x7f4a7c15
    v_mov_b32 v23, s72
    v_mov_b32 v87, s72
    s_mov_b32 exec_lo, 1
    s_mov_b32 exec_hi, 1
    buffer_store_dwordx2 v[22:23], v29, s[64:67], 0 offen sc1
    s_mov_b64 exec, -1
    s_mov_b32 s84, s26
    s_mov_b32 s85, s27
    s_mov_b32 s86, 2752
    s_mov_b32 s87, 0x20000
    buffer_load_ushort v56, v47, s[84:87], 0 offen offset:0
    buffer_load_ushort v57, v47, s[84:87], 0 offen offset:64
    buffer_load_ushort v58, v47, s[84:87], 0 offen offset:128
    global_load_dwordx2 v[24:25], v48, s[20:21]
    global_load_dwordx2 v[26:27], v48, s[30:31]
    s_add_u32 m0, s78, 16384
    s_movk_i32 s81, 128
    buffer_load_dwordx4 v32, s[40:43], s81 offen offset:0  lds
    buffer_load_dwordx4 v33, s[40:43], s81 offen offset:1024  lds
    buffer_load_dwordx4 v34, s[40:43], s81 offen offset:2048  lds
    buffer_load_dwordx4 v35, s[40:43], s81 offen offset:3072  lds
    s_add_u32 m0, s79, 73728
    s_nop 0
    buffer_load_dwordx4 v36, s[44:47], s81 offen offset:0 lds
    buffer_load_dwordx4 v37, s[44:47], s81 offen offset:1024 lds
    s_add_u32 m0, s78, 32768
    s_movk_i32 s81, 256
    buffer_load_dwordx4 v32, s[40:43], s81 offen offset:0  lds
    buffer_load_dwordx4 v33, s[40:43], s81 offen offset:1024  lds
    buffer_load_dwordx4 v34, s[40:43], s81 offen offset:2048  lds
    buffer_load_dwordx4 v35, s[40:43], s81 offen offset:3072  lds
    s_add_u32 m0, s79, 81920
    s_nop 0
    buffer_load_dwordx4 v36, s[44:47], s81 offen offset:0 lds
    buffer_load_dwordx4 v37, s[44:47], s81 offen offset:1024 lds
    s_waitcnt vmcnt(23) lgkmcnt(0)
    s_barrier
    ds_read_b128 a[0:3], v59 offset:0
    ds_read_b128 v[164:167], v63 offset:0
    ds_read_b128 v[168:171], v63 offset:4096
    ds_read_b128 a[4:7], v60 offset:0
    s_add_u32 m0, s78, 49152
    s_movk_i32 s81, 384
    buffer_load_dwordx4 v32, s[40:43], s81 offen offset:0  lds
    ds_read_b128 v[172:175], v64 offset:0
    ds_read_b128 v[176:179], v64 offset:4096
    ds_read_b128 a[8:11], v61 offset:0
    ds_read_b128 v[180:183], v65 offset:0
    buffer_load_dwordx4 v33, s[40:43], s81 offen offset:1024  lds
    ds_read_b128 v[184:187], v65 offset:4096
    ds_read_b128 a[12:15], v62 offset:0
    ds_read_b128 v[188:191], v66 offset:0
    ds_read_b128 v[192:195], v66 offset:4096
    buffer_load_dwordx4 v34, s[40:43], s81 offen offset:2048  lds
    v_lshlrev_b32 v53, 16, v53
    v_lshlrev_b32 v54, 16, v54
    v_lshlrev_b32 v55, 16, v55
    v_mul_f32 v55, 0x3fb8aa3b, v55
    v_exp_f32 v55, v55
    buffer_load_dwordx4 v35, s[40:43], s81 offen offset:3072  lds
    s_nop 0
    v_cvt_pk_bf16_f32 v55, v55, v55
    v_lshlrev_b32 v55, 16, v55
    v_mul_f32 v9, v55, v53
    s_add_u32 m0, s79, 90112
    s_nop 0
    buffer_load_dwordx4 v36, s[44:47], s81 offen offset:0 lds
    v_mul_f32 v11, v55, v54
    v_mul_f32 v9, 0x3fb8aa3b, v9
    v_mul_f32 v11, 0.15915494, v11
    v_mul_f32 v1, 1.0, v9
    buffer_load_dwordx4 v37, s[44:47], s81 offen offset:1024 lds
    s_waitcnt vmcnt(12) lgkmcnt(0)
    s_barrier
    v_mfma_f32_32x32x16_bf16 v[228:243], a[0:3], v[164:167], 0
    ds_read_b128 a[16:19], v59 offset:16384
    ds_read_b128 v[132:135], v63 offset:8192
    v_mul_f32 v2, 1.0, v11
    v_exp_f32 v1, v1
    v_mfma_f32_32x32x16_bf16 v[212:227], a[0:3], v[168:171], 0
    ds_read_b128 v[136:139], v63 offset:12288
    ds_read_b128 a[20:23], v60 offset:16384
    s_add_u32 m0, s78, 0
    s_movk_i32 s81, 512
    buffer_load_dwordx4 v32, s[40:43], s81 offen offset:0  lds
    v_fract_f32 v2, v2
    v_mfma_f32_32x32x16_bf16 v[196:211], v[244:247], v[164:167], 0
    ds_read_b128 v[140:143], v64 offset:8192
    ds_read_b128 v[144:147], v64 offset:12288
    buffer_load_dwordx4 v33, s[40:43], s81 offen offset:1024  lds
    v_cos_f32 v22, v2
    v_mfma_f32_32x32x16_bf16 v[228:243], a[4:7], v[172:175], v[228:243]
    ds_read_b128 a[24:27], v61 offset:16384
    v_sin_f32 v23, v2
    v_mul_f32 v22, v1, v22
    v_mfma_f32_32x32x16_bf16 v[212:227], a[4:7], v[176:179], v[212:227]
    ds_read_b128 v[148:151], v65 offset:8192
    ds_read_b128 v[152:155], v65 offset:12288
    buffer_load_dwordx4 v34, s[40:43], s81 offen offset:2048  lds
    v_mul_f32 v23, -v1, v23
    v_mfma_f32_32x32x16_bf16 v[196:211], v[248:251], v[168:171], v[196:211]
    ds_read_b128 a[28:31], v62 offset:16384
    ds_read_b128 v[156:159], v66 offset:8192
    v_add_f32 v1, -1.0, v22
    v_mul_f32 v2, v53, v53
    v_mfma_f32_32x32x16_bf16 v[228:243], a[8:11], v[180:183], v[228:243]
    ds_read_b128 v[160:163], v66 offset:12288
    buffer_load_dwordx4 v35, s[40:43], s81 offen offset:3072  lds
    v_fmac_f32 v2, v54, v54
    v_mfma_f32_32x32x16_bf16 v[212:227], a[8:11], v[184:187], v[212:227]
    s_add_u32 m0, s79, 65536
    s_nop 0
    buffer_load_dwordx4 v36, s[44:47], s81 offen offset:0 lds
    v_rcp_f32 v2, v2
    v_mfma_f32_32x32x16_bf16 v[228:243], a[12:15], v[188:191], v[228:243]
    v_mul_f32 v28, v1, v53
    v_fma_f32 v28, -v23, v54, v28
    v_mfma_f32_32x32x16_bf16 v[212:227], a[12:15], v[192:195], v[212:227]
    buffer_load_dwordx4 v37, s[44:47], s81 offen offset:1024 lds
    v_mul_f32 v29, v1, v54
    s_waitcnt vmcnt(12) lgkmcnt(0)
    s_barrier
    v_mfma_f32_32x32x16_bf16 v[228:243], a[16:19], v[132:135], v[228:243]
    ds_read_b128 a[32:35], v59 offset:32768
    ds_read_b128 v[164:167], v63 offset:16384
    s_add_u32 m0, s78, 16384
    s_movk_i32 s81, 640
    buffer_load_dwordx4 v32, s[40:43], s81 offen offset:0  lds
    v_fmac_f32 v29, v23, v53
    v_mfma_f32_32x32x16_bf16 v[212:227], a[16:19], v[136:139], v[212:227]
    ds_read_b128 v[168:171], v63 offset:20480
    ds_read_b128 a[36:39], v60 offset:32768
    v_add_f32 v2, v2, v2
    v_mul_f32 v28, v28, v2
    v_mfma_f32_32x32x16_bf16 v[196:211], v[244:247], v[132:135], v[196:211]
    ds_read_b128 v[172:175], v64 offset:16384
    ds_read_b128 v[176:179], v64 offset:20480
    buffer_load_dwordx4 v33, s[40:43], s81 offen offset:1024  lds
    v_mul_f32 v29, v29, v2
    v_mfma_f32_32x32x16_bf16 v[228:243], a[20:23], v[140:143], v[228:243]
    ds_read_b128 a[40:43], v61 offset:32768
    buffer_load_dwordx4 v34, s[40:43], s81 offen offset:2048  lds
    v_mul_f32 v1, 0x41800000, v9
    v_mfma_f32_32x32x16_bf16 v[212:227], a[20:23], v[144:147], v[212:227]
    ds_read_b128 v[180:183], v65 offset:16384
    ds_read_b128 v[184:187], v65 offset:20480
    v_mul_f32 v2, 0x41800000, v11
    v_exp_f32 v1, v1
    v_mfma_f32_32x32x16_bf16 v[196:211], v[248:251], v[136:139], v[196:211]
    ds_read_b128 a[44:47], v62 offset:32768
    ds_read_b128 v[188:191], v66 offset:16384
    buffer_load_dwordx4 v35, s[40:43], s81 offen offset:3072  lds
    v_fract_f32 v2, v2
    v_mfma_f32_32x32x16_bf16 v[228:243], a[24:27], v[148:151], v[228:243]
    ds_read_b128 v[192:195], v66 offset:20480
    s_add_u32 m0, s79, 73728
    s_nop 0
    buffer_load_dwordx4 v36, s[44:47], s81 offen offset:0 lds
    v_cos_f32 v30, v2
    v_mfma_f32_32x32x16_bf16 v[212:227], a[24:27], v[152:155], v[212:227]
    v_sin_f32 v31, v2
    v_mul_f32 v30, v1, v30
    v_mfma_f32_32x32x16_bf16 v[228:243], a[28:31], v[156:159], v[228:243]
    buffer_load_dwordx4 v37, s[44:47], s81 offen offset:1024 lds
    v_mul_f32 v31, -v1, v31
    v_mfma_f32_32x32x16_bf16 v[212:227], a[28:31], v[160:163], v[212:227]
    s_mov_b64 exec, 255
    buffer_load_dword v5, v51, s[8:11], 0 offen
    s_mov_b64 exec, 2047
    buffer_load_dword v5, v52, s[60:63], 0 offen
    s_mov_b64 exec, -1
    v_mul_f32 v1, 0x42000000, v9
    s_waitcnt vmcnt(14) lgkmcnt(0)
    s_barrier
    v_mfma_f32_32x32x16_bf16 v[228:243], a[32:35], v[164:167], v[228:243]
    ds_read_b128 a[48:51], v59 offset:49152
    ds_read_b128 v[132:135], v63 offset:24576
    v_mul_f32 v2, 0x42000000, v11
    v_exp_f32 v1, v1
    v_mfma_f32_32x32x16_bf16 v[212:227], a[32:35], v[168:171], v[212:227]
    ds_read_b128 v[136:139], v63 offset:28672
    ds_read_b128 a[52:55], v60 offset:49152
    s_add_u32 m0, s78, 32768
    s_movk_i32 s81, 768
    buffer_load_dwordx4 v32, s[40:43], s81 offen offset:0  lds
    v_fract_f32 v2, v2
    v_mfma_f32_32x32x16_bf16 v[196:211], v[244:247], v[164:167], v[196:211]
    ds_read_b128 v[140:143], v64 offset:24576
    ds_read_b128 v[144:147], v64 offset:28672
    buffer_load_dwordx4 v33, s[40:43], s81 offen offset:1024  lds
    v_cos_f32 v38, v2
    v_mfma_f32_32x32x16_bf16 v[228:243], a[36:39], v[172:175], v[228:243]
    ds_read_b128 a[56:59], v61 offset:49152
    v_sin_f32 v39, v2
    v_mul_f32 v38, v1, v38
    v_mfma_f32_32x32x16_bf16 v[212:227], a[36:39], v[176:179], v[212:227]
    ds_read_b128 v[148:151], v65 offset:24576
    ds_read_b128 v[152:155], v65 offset:28672
    buffer_load_dwordx4 v34, s[40:43], s81 offen offset:2048  lds
    v_mul_f32 v39, -v1, v39
    v_mfma_f32_32x32x16_bf16 v[196:211], v[248:251], v[168:171], v[196:211]
    ds_read_b128 a[60:63], v62 offset:49152
    ds_read_b128 v[156:159], v66 offset:24576
    s_lshl_b32 s83, s3, 5
    v_lshl_add_u32 v3, v8, 4, s83
    v_mfma_f32_32x32x16_bf16 v[228:243], a[40:43], v[180:183], v[228:243]
    ds_read_b128 v[160:163], v66 offset:28672
    buffer_load_dwordx4 v35, s[40:43], s81 offen offset:3072  lds
    v_cvt_f32_u32 v3, v3
    v_mfma_f32_32x32x16_bf16 v[212:227], a[40:43], v[184:187], v[212:227]
    s_add_u32 m0, s79, 81920
    s_nop 0
    buffer_load_dwordx4 v36, s[44:47], s81 offen offset:0 lds
    v_mul_f32 v1, v3, v9
    v_mfma_f32_32x32x16_bf16 v[228:243], a[44:47], v[188:191], v[228:243]
    v_mul_f32 v2, v3, v11
    v_exp_f32 v1, v1
    v_mfma_f32_32x32x16_bf16 v[212:227], a[44:47], v[192:195], v[212:227]
    buffer_load_dwordx4 v37, s[44:47], s81 offen offset:1024 lds
    v_fract_f32 v2, v2
    s_waitcnt vmcnt(14) lgkmcnt(0)
    s_barrier
    v_mfma_f32_32x32x16_bf16 v[228:243], a[48:51], v[132:135], v[228:243]
    ds_read_b128 a[64:67], v59 offset:0
    ds_read_b128 v[164:167], v63 offset:0
    v_cos_f32 v40, v2
    v_mfma_f32_32x32x16_bf16 v[212:227], a[48:51], v[136:139], v[212:227]
    ds_read_b128 v[168:171], v63 offset:4096
    ds_read_b128 a[68:71], v60 offset:0
    s_add_u32 m0, s78, 49152
    s_movk_i32 s81, 896
    buffer_load_dwordx4 v32, s[40:43], s81 offen offset:0  lds
    v_sin_f32 v41, v2
    v_mul_f32 v40, v1, v40
    v_mfma_f32_32x32x16_bf16 v[196:211], v[244:247], v[132:135], v[196:211]
    ds_read_b128 v[172:175], v64 offset:0
    ds_read_b128 v[176:179], v64 offset:4096
    buffer_load_dwordx4 v33, s[40:43], s81 offen offset:1024  lds
    v_mul_f32 v41, -v1, v41
    v_mfma_f32_32x32x16_bf16 v[228:243], a[52:55], v[140:143], v[228:243]
    ds_read_b128 a[72:75], v61 offset:0
    s_lshl_b32 s83, s3, 2
    v_mfma_f32_32x32x16_bf16 v[212:227], a[52:55], v[144:147], v[212:227]
    ds_read_b128 v[180:183], v65 offset:0
    ds_read_b128 v[184:187], v65 offset:4096
    buffer_load_dwordx4 v34, s[40:43], s81 offen offset:2048  lds
    v_lshl_add_u32 v4, v8, 1, s83
    s_lshl_b32 s82, s39, 13
    v_mfma_f32_32x32x16_bf16 v[196:211], v[248:251], v[136:139], v[196:211]
    ds_read_b128 a[76:79], v62 offset:0
    ds_read_b128 v[188:191], v66 offset:0
    s_add_u32 s82, s82, 32768
    v_mfma_f32_32x32x16_bf16 v[228:243], a[56:59], v[148:151], v[228:243]
    ds_read_b128 v[192:195], v66 offset:4096
    buffer_load_dwordx4 v35, s[40:43], s81 offen offset:3072  lds
    v_lshlrev_b32 v3, 4, v7
    v_mfma_f32_32x32x16_bf16 v[212:227], a[56:59], v[152:155], v[212:227]
    s_add_u32 m0, s79, 90112
    s_nop 0
    buffer_load_dwordx4 v36, s[44:47], s81 offen offset:0 lds
    v_lshl_add_u32 v3, v4, 9, v3
    v_add_u32 v3, s82, v3
    v_mfma_f32_32x32x16_bf16 v[228:243], a[60:63], v[156:159], v[228:243]
    v_mov_b32 v2, 1073741824
    v_mfma_f32_32x32x16_bf16 v[212:227], a[60:63], v[160:163], v[212:227]
    buffer_load_dwordx4 v37, s[44:47], s81 offen offset:1024 lds
    v_cmp_gt_u32 s[90:91], s38, v4
    s_waitcnt vmcnt(14) lgkmcnt(0)
    s_barrier
    v_mfma_f32_32x32x16_bf16 v[228:243], a[64:67], v[164:167], v[228:243]
    ds_read_b128 a[80:83], v59 offset:16384
    ds_read_b128 v[132:135], v63 offset:8192
    v_add_u32 v1, 1, v4
    v_cmp_gt_u32 s[92:93], s38, v1
    v_mfma_f32_32x32x16_bf16 v[212:227], a[64:67], v[168:171], v[212:227]
    ds_read_b128 v[136:139], v63 offset:12288
    ds_read_b128 a[84:87], v60 offset:16384
    v_cndmask_b32 v91, v2, v3, s[90:91]
    v_mfma_f32_32x32x16_bf16 v[196:211], v[244:247], v[164:167], v[196:211]
    ds_read_b128 v[140:143], v64 offset:8192
    ds_read_b128 v[144:147], v64 offset:12288
    s_add_u32 m0, s80, 98304
    s_mov_b32 s81, 0
    buffer_load_dwordx4 v67, s[48:51], s81 offen offset:0 lds
    v_sub_u32 v4, s38, v1
    v_mfma_f32_32x32x16_bf16 v[228:243], a[68:71], v[172:175], v[228:243]
    ds_read_b128 a[88:91], v61 offset:16384
    v_cndmask_b32 v92, v2, v3, s[92:93]
    v_max_i32 v3, 0, v4
    v_mfma_f32_32x32x16_bf16 v[212:227], a[68:71], v[176:179], v[212:227]
    ds_read_b128 v[148:151], v65 offset:8192
    ds_read_b128 v[152:155], v65 offset:12288
    v_lshlrev_b32 v3, 7, v3
    v_mfma_f32_32x32x16_bf16 v[196:211], v[248:251], v[168:171], v[196:211]
    ds_read_b128 a[92:95], v62 offset:16384
    ds_read_b128 v[156:159], v66 offset:8192
    v_cvt_f32_u32 v3, v3
    v_mul_f32 v1, v3, v9
    v_mfma_f32_32x32x16_bf16 v[228:243], a[72:75], v[180:183], v[228:243]
    ds_read_b128 v[160:163], v66 offset:12288
    buffer_load_dwordx4 v68, s[48:51], s81 offen offset:1024 lds
    v_mul_f32 v2, v3, v11
    v_mfma_f32_32x32x16_bf16 v[212:227], a[72:75], v[184:187], v[212:227]
    v_exp_f32 v1, v1
    v_mfma_f32_32x32x16_bf16 v[228:243], a[76:79], v[188:191], v[228:243]
    v_fract_f32 v2, v2
    v_cos_f32 v42, v2
    v_mfma_f32_32x32x16_bf16 v[212:227], a[76:79], v[192:195], v[212:227]
    buffer_load_dwordx4 v69, s[48:51], s81 offen offset:2048 lds
    v_sin_f32 v43, v2
    s_waitcnt vmcnt(9) lgkmcnt(0)
    s_barrier
    v_mfma_f32_32x32x16_bf16 v[228:243], a[80:83], v[132:135], v[228:243]
    ds_read_b128 a[96:99], v59 offset:32768
    ds_read_b128 v[164:167], v63 offset:16384
    v_mul_f32 v42, v1, v42
    v_mul_f32 v43, -v1, v43
    v_mfma_f32_32x32x16_bf16 v[212:227], a[80:83], v[136:139], v[212:227]
    ds_read_b128 v[168:171], v63 offset:20480
    ds_read_b128 a[100:103], v60 offset:32768
    buffer_load_dwordx2 v[74:75], v50, s[64:67], 0 offen sc1
    v_add_u32 v4, -1, v4
    v_mfma_f32_32x32x16_bf16 v[196:211], v[244:247], v[132:135], v[196:211]
    ds_read_b128 v[172:175], v64 offset:16384
    ds_read_b128 v[176:179], v64 offset:20480
    v_max_i32 v3, 0, v4
    v_mfma_f32_32x32x16_bf16 v[228:243], a[84:87], v[140:143], v[228:243]
    ds_read_b128 a[104:107], v61 offset:32768
    v_lshlrev_b32 v3, 7, v3
    v_cvt_f32_u32 v3, v3
    v_mfma_f32_32x32x16_bf16 v[212:227], a[84:87], v[144:147], v[212:227]
    ds_read_b128 v[180:183], v65 offset:16384
    ds_read_b128 v[184:187], v65 offset:20480
    s_add_u32 m0, s80, 110592
    s_mov_b32 s81, 176128
    buffer_load_dwordx4 v67, s[48:51], s81 offen offset:0 lds
    v_mul_f32 v1, v3, v9
    v_mfma_f32_32x32x16_bf16 v[196:211], v[248:251], v[136:139], v[196:211]
    ds_read_b128 a[108:111], v62 offset:32768
    ds_read_b128 v[188:191], v66 offset:16384
    v_mul_f32 v2, v3, v11
    v_exp_f32 v1, v1
    v_mfma_f32_32x32x16_bf16 v[228:243], a[88:91], v[148:151], v[228:243]
    ds_read_b128 v[192:195], v66 offset:20480
    v_fract_f32 v2, v2
    v_mfma_f32_32x32x16_bf16 v[212:227], a[88:91], v[152:155], v[212:227]
    buffer_load_dwordx4 v68, s[48:51], s81 offen offset:1024 lds
    v_cos_f32 v44, v2
    v_mfma_f32_32x32x16_bf16 v[228:243], a[92:95], v[156:159], v[228:243]
    v_sin_f32 v45, v2
    v_mul_f32 v44, v1, v44
    v_mfma_f32_32x32x16_bf16 v[212:227], a[92:95], v[160:163], v[212:227]
    buffer_load_dwordx4 v69, s[48:51], s81 offen offset:2048 lds
    v_mul_f32 v45, -v1, v45
    s_waitcnt vmcnt(7) lgkmcnt(0)
    s_barrier
    v_mfma_f32_32x32x16_bf16 v[228:243], a[96:99], v[164:167], v[228:243]
    ds_read_b128 a[112:115], v59 offset:49152
    ds_read_b128 v[132:135], v63 offset:24576
    s_add_u32 m0, s79, 36864
    s_nop 0
    buffer_load_dwordx4 v80, s[40:43], 0 offen offset:0 lds
    v_mfma_f32_32x32x16_bf16 v[212:227], a[96:99], v[168:171], v[212:227]
    ds_read_b128 v[136:139], v63 offset:28672
    ds_read_b128 a[116:119], v60 offset:49152
    buffer_load_dwordx4 v81, s[40:43], 0 offen offset:1024 lds
    v_mfma_f32_32x32x16_bf16 v[196:211], v[244:247], v[164:167], v[196:211]
    ds_read_b128 v[140:143], v64 offset:24576
    ds_read_b128 v[144:147], v64 offset:28672
    v_mfma_f32_32x32x16_bf16 v[228:243], a[100:103], v[172:175], v[228:243]
    ds_read_b128 a[120:123], v61 offset:49152
    s_add_u32 m0, s80, 122880
    s_mov_b32 s81, 352256
    buffer_load_dwordx4 v67, s[48:51], s81 offen offset:0 lds
    v_mfma_f32_32x32x16_bf16 v[212:227], a[100:103], v[176:179], v[212:227]
    ds_read_b128 v[148:151], v65 offset:24576
    ds_read_b128 v[152:155], v65 offset:28672
    buffer_load_dwordx4 v68, s[48:51], s81 offen offset:1024 lds
    v_mfma_f32_32x32x16_bf16 v[196:211], v[248:251], v[168:171], v[196:211]
    ds_read_b128 a[124:127], v62 offset:49152
    ds_read_b128 v[156:159], v66 offset:24576
    buffer_load_dwordx4 v69, s[48:51], s81 offen offset:2048 lds
    v_mfma_f32_32x32x16_bf16 v[228:243], a[104:107], v[180:183], v[228:243]
    ds_read_b128 v[160:163], v66 offset:28672
    v_mfma_f32_32x32x16_bf16 v[212:227], a[104:107], v[184:187], v[212:227]
    s_add_u32 m0, s80, 135168
    s_mov_b32 s81, 528384
    buffer_load_dwordx4 v67, s[48:51], s81 offen offset:0 lds
    v_mfma_f32_32x32x16_bf16 v[228:243], a[108:111], v[188:191], v[228:243]
    buffer_load_dwordx4 v68, s[48:51], s81 offen offset:1024 lds
    v_mfma_f32_32x32x16_bf16 v[212:227], a[108:111], v[192:195], v[212:227]
    buffer_load_dwordx4 v69, s[48:51], s81 offen offset:2048 lds
    s_waitcnt lgkmcnt(0)
    v_mfma_f32_32x32x16_bf16 v[228:243], a[112:115], v[132:135], v[228:243]
    s_waitcnt vmcnt(11)
    v_cmp_ne_u32 vcc, s72, v75
    s_cbranch_vccnz L_slow_st
L_back_st:
    v_and_b32 v1, 0xffff0000, v74
    v_rcp_f32 v46, v1
    v_mfma_f32_32x32x16_bf16 v[212:227], a[112:115], v[136:139], v[212:227]
    v_cmp_gt_u32 vcc, 32, v0
    ds_write_b32 v49, v74 offset:512
    v_mfma_f32_32x32x16_bf16 v[196:211], v[244:247], v[132:135], v[196:211]
    ds_write_b32 v49, v46
    v_xor_b32 v2, 0x8000, v74
    v_and_b32 v2, 0xffff, v2
    v_mfma_f32_32x32x16_bf16 v[196:211], v[248:251], v[136:139], v[196:211]
    v_lshl_or_b32 v2, v2, 16, v2
    v_lshrrev_b32 v1, 16, v74
    v_cndmask_b32 v94, 0, v2, vcc
    s_add_u32 m0, s80, 147456
    s_mov_b32 s81, 704512
    buffer_load_dwordx4 v67, s[48:51], s81 offen offset:0 lds
    v_mfma_f32_32x32x16_bf16 v[228:243], a[116:119], v[140:143], v[228:243]
    v_cndmask_b32 v95, 0, v1, vcc
    v_mov_b32 v96, 0
    v_mov_b32 v97, 0
    v_mfma_f32_32x32x16_bf16 v[212:227], a[116:119], v[144:147], v[212:227]
    v_mov_b32 v99, 0
    v_mov_b32 v100, 0
    v_mov_b32 v101, 0
    buffer_load_dwordx4 v68, s[48:51], s81 offen offset:1024 lds
    v_mfma_f32_32x32x16_bf16 v[228:243], a[120:123], v[148:151], v[228:243]
    v_add_u32 v3, 161792, v82
    v_mfma_f32_32x32x16_bf16 v[212:227], a[120:123], v[152:155], v[212:227]
    buffer_load_dwordx4 v69, s[48:51], s81 offen offset:2048 lds
    s_mov_b32 exec_hi, 0
    ds_write_b32 v3, v196
    ds_write_b32 v3, v197 offset:512
    s_mov_b64 exec, -1
    s_waitcnt vmcnt(15) lgkmcnt(0)
    s_barrier
    v_mfma_f32_32x32x16_bf16 v[228:243], a[124:127], v[156:159], v[228:243]
    ds_read_b128 v[180:183], v90 offset:14336
    ds_read_b128 v[184:187], v90 offset:14848
    s_lshl_b32 s82, s3, 7
    s_add_u32 s82, s82, 159744
    v_lshl_add_u32 v4, v8, 6, s82
    ds_read_b64_tr_b16 v[32:33], v70 offset:0
    ds_read_b64_tr_b16 v[34:35], v70 offset:768
    ds_read_b64_tr_b16 v[48:49], v70 offset:64
    ds_read_b64_tr_b16 v[50:51], v70 offset:832
    ds_read_b64_tr_b16 v[52:53], v70 offset:128
    ds_read_b64_tr_b16 v[54:55], v70 offset:896
    s_add_u32 m0, s80, 0
    s_mov_b32 s81, 880640
    buffer_load_dwordx4 v67, s[48:51], s81 offen offset:0 lds
    v_mfma_f32_32x32x16_bf16 v[212:227], a[124:127], v[160:163], v[212:227]
    ds_read_b128 v[164:167], v4 offset:0
    ds_read_b128 v[168:171], v4 offset:16
    ds_read_b128 v[172:175], v4 offset:32
    ds_read_b128 v[176:179], v4 offset:48
    buffer_load_dwordx4 v68, s[48:51], s81 offen offset:1024 lds
    buffer_load_dwordx4 v69, s[48:51], s81 offen offset:2048 lds
    s_waitcnt lgkmcnt(10)
    v_add_f32 v180, v180, v181
    v_add_f32 v182, v182, v183
    ds_read_b64_tr_b16 v[60:61], v71 offset:0
    v_add_f32 v180, v180, v182
    v_cvt_pk_bf16_f32 v181, v180, v180
    ds_read_b64_tr_b16 v[62:63], v71 offset:768
    v_lshlrev_b32 v182, 16, v181
    v_sub_f32 v180, v180, v182
    ds_read_b64_tr_b16 v[110:111], v71 offset:64
    v_cvt_pk_bf16_f32 v98, v182, v180
    ds_read_b64_tr_b16 v[112:113], v71 offset:832
    s_nop 1
    v_mfma_f32_32x32x16_bf16 v[228:243], v[94:97], v[98:101], v[228:243]
    ds_read_b64_tr_b16 v[114:115], v71 offset:128
    v_add_f32 v184, v184, v185
    ds_read_b64_tr_b16 v[116:117], v71 offset:896
    v_add_f32 v186, v186, v187
    v_add_f32 v184, v184, v186
    v_cvt_pk_bf16_f32 v185, v184, v184
    v_lshlrev_b32 v186, 16, v185
    v_sub_f32 v184, v184, v186
    v_cvt_pk_bf16_f32 v98, v186, v184
    s_nop 1
    v_mfma_f32_32x32x16_bf16 v[212:227], v[94:97], v[98:101], v[212:227]
    s_waitcnt lgkmcnt(10)
    v_mfma_f32_32x32x16_bf16 v[148:163], v[32:35], a[0:3], 0
    ds_read_b64_tr_b16 v[118:119], v72 offset:0
    ds_read_b64_tr_b16 v[120:121], v72 offset:768
    ds_read_b64_tr_b16 v[122:123], v72 offset:64
    v_mfma_f32_32x32x16_bf16 v[196:211], v[244:247], v[32:35], 0
    ds_read_b64_tr_b16 v[124:125], v72 offset:832
    ds_read_b64_tr_b16 v[126:127], v72 offset:128
    v_mfma_f32_32x32x16_bf16 v[180:195], v[48:51], a[0:3], 0
    ds_read_b64_tr_b16 v[128:129], v72 offset:896
    v_mfma_f32_32x32x16_bf16 v[132:147], v[52:55], a[0:3], 0
    s_waitcnt lgkmcnt(12)
    v_pk_mul_f32 v[102:103], v[28:29], v[228:229] op_sel:[0,0] op_sel_hi:[1,0]
    v_pk_fma_f32 v[102:103], v[28:29], v[212:213], v[102:103] op_sel:[1,0,0] op_sel_hi:[0,0,1] neg_hi:[1,0,0]
    v_pk_mul_f32 v[104:105], v[28:29], v[228:229] op_sel:[0,1] op_sel_hi:[1,1]
    v_pk_fma_f32 v[104:105], v[28:29], v[212:213], v[104:105] op_sel:[1,1,0] op_sel_hi:[0,1,1] neg_hi:[1,0,0]
    v_pk_mul_f32 v[228:229], v[102:103], v[164:165] op_sel:[0,0] op_sel_hi:[1,0]
    v_pk_mul_f32 v[212:213], v[104:105], v[164:165] op_sel:[0,1] op_sel_hi:[1,1]
    v_pk_fma_f32 v[106:107], v[22:23], v[228:229], v[212:213] op_sel:[0,0,0] op_sel_hi:[0,1,1]
    v_pk_fma_f32 v[108:109], v[22:23], v[228:229], v[106:107] op_sel:[1,1,0] op_sel_hi:[1,0,1] neg_lo:[1,0,0]
    v_pk_mul_f32 v[102:103], v[28:29], v[230:231] op_sel:[0,0] op_sel_hi:[1,0]
    v_pk_fma_f32 v[102:103], v[28:29], v[214:215], v[102:103] op_sel:[1,0,0] op_sel_hi:[0,0,1] neg_hi:[1,0,0]
    v_pk_mul_f32 v[104:105], v[28:29], v[230:231] op_sel:[0,1] op_sel_hi:[1,1]
    v_pk_fma_f32 v[104:105], v[28:29], v[214:215], v[104:105] op_sel:[1,1,0] op_sel_hi:[0,1,1] neg_hi:[1,0,0]
    v_pk_mul_f32 v[230:231], v[102:103], v[166:167] op_sel:[0,0] op_sel_hi:[1,0]
    v_pk_fma_f32 v[106:107], v[22:23], v[108:109], v[230:231] op_sel:[0,0,0] op_sel_hi:[0,1,1]
    v_pk_fma_f32 v[108:109], v[22:23], v[108:109], v[106:107] op_sel:[1,1,0] op_sel_hi:[1,0,1] neg_lo:[1,0,0]
    v_pk_mul_f32 v[214:215], v[104:105], v[166:167] op_sel:[0,1] op_sel_hi:[1,1]
    v_pk_fma_f32 v[106:107], v[22:23], v[108:109], v[214:215] op_sel:[0,0,0] op_sel_hi:[0,1,1]
    v_pk_fma_f32 v[108:109], v[22:23], v[108:109], v[106:107] op_sel:[1,1,0] op_sel_hi:[1,0,1] neg_lo:[1,0,0]
    v_pk_mul_f32 v[102:103], v[28:29], v[232:233] op_sel:[0,0] op_sel_hi:[1,0]
    v_pk_fma_f32 v[102:103], v[28:29], v[216:217], v[102:103] op_sel:[1,0,0] op_sel_hi:[0,0,1] neg_hi:[1,0,0]
    v_pk_mul_f32 v[104:105], v[28:29], v[232:233] op_sel:[0,1] op_sel_hi:[1,1]
    v_pk_fma_f32 v[104:105], v[28:29], v[216:217], v[104:105] op_sel:[1,1,0] op_sel_hi:[0,1,1] neg_hi:[1,0,0]
    v_pk_mul_f32 v[232:233], v[102:103], v[168:169] op_sel:[0,0] op_sel_hi:[1,0]
    v_pk_fma_f32 v[106:107], v[22:23], v[108:109], v[232:233] op_sel:[0,0,0] op_sel_hi:[0,1,1]
    v_pk_fma_f32 v[108:109], v[22:23], v[108:109], v[106:107] op_sel:[1,1,0] op_sel_hi:[1,0,1] neg_lo:[1,0,0]
    v_pk_mul_f32 v[216:217], v[104:105], v[168:169] op_sel:[0,1] op_sel_hi:[1,1]
    v_pk_fma_f32 v[106:107], v[22:23], v[108:109], v[216:217] op_sel:[0,0,0] op_sel_hi:[0,1,1]
    v_pk_fma_f32 v[108:109], v[22:23], v[108:109], v[106:107] op_sel:[1,1,0] op_sel_hi:[1,0,1] neg_lo:[1,0,0]
    v_pk_mul_f32 v[102:103], v[28:29], v[234:235] op_sel:[0,0] op_sel_hi:[1,0]
    v_pk_fma_f32 v[102:103], v[28:29], v[218:219], v[102:103] op_sel:[1,0,0] op_sel_hi:[0,0,1] neg_hi:[1,0,0]
    v_pk_mul_f32 v[104:105], v[28:29], v[234:235] op_sel:[0,1] op_sel_hi:[1,1]
    v_pk_fma_f32 v[104:105], v[28:29], v[218:219], v[104:105] op_sel:[1,1,0] op_sel_hi:[0,1,1] neg_hi:[1,0,0]
    v_pk_mul_f32 v[234:235], v[102:103], v[170:171] op_sel:[0,0] op_sel_hi:[1,0]
    v_pk_fma_f32 v[106:107], v[22:23], v[108:109], v[234:235] op_sel:[0,0,0] op_sel_hi:[0,1,1]
    v_pk_fma_f32 v[108:109], v[22:23], v[108:109], v[106:107] op_sel:[1,1,0] op_sel_hi:[1,0,1] neg_lo:[1,0,0]
    v_pk_mul_f32 v[218:219], v[104:105], v[170:171] op_sel:[0,1] op_sel_hi:[1,1]
    v_pk_fma_f32 v[106:107], v[22:23], v[108:109], v[218:219] op_sel:[0,0,0] op_sel_hi:[0,1,1]
    v_pk_fma_f32 v[108:109], v[22:23], v[108:109], v[106:107] op_sel:[1,1,0] op_sel_hi:[1,0,1] neg_lo:[1,0,0]
    v_pk_mul_f32 v[102:103], v[28:29], v[236:237] op_sel:[0,0] op_sel_hi:[1,0]
    v_pk_fma_f32 v[102:103], v[28:29], v[220:221], v[102:103] op_sel:[1,0,0] op_sel_hi:[0,0,1] neg_hi:[1,0,0]
    v_pk_mul_f32 v[104:105], v[28:29], v[236:237] op_sel:[0,1] op_sel_hi:[1,1]
    s_add_u32 m0, s80, 12288
    s_mov_b32 s81, 1056768
    buffer_load_dwordx4 v67, s[48:51], s81 offen offset:0 lds
    v_pk_fma_f32 v[104:105], v[28:29], v[220:221], v[104:105] op_sel:[1,1,0] op_sel_hi:[0,1,1] neg_hi:[1,0,0]
    v_pk_mul_f32 v[236:237], v[102:103], v[172:173] op_sel:[0,0] op_sel_hi:[1,0]
    v_pk_fma_f32 v[106:107], v[22:23], v[108:109], v[236:237] op_sel:[0,0,0] op_sel_hi:[0,1,1]
    v_pk_fma_f32 v[108:109], v[22:23], v[108:109], v[106:107] op_sel:[1,1,0] op_sel_hi:[1,0,1] neg_lo:[1,0,0]
    v_pk_mul_f32 v[220:221], v[104:105], v[172:173] op_sel:[0,1] op_sel_hi:[1,1]
    v_pk_fma_f32 v[106:107], v[22:23], v[108:109], v[220:221] op_sel:[0,0,0] op_sel_hi:[0,1,1]
    v_pk_fma_f32 v[108:109], v[22:23], v[108:109], v[106:107] op_sel:[1,1,0] op_sel_hi:[1,0,1] neg_lo:[1,0,0]
    v_pk_mul_f32 v[102:103], v[28:29], v[238:239] op_sel:[0,0] op_sel_hi:[1,0]
    v_pk_fma_f32 v[102:103], v[28:29], v[222:223], v[102:103] op_sel:[1,0,0] op_sel_hi:[0,0,1] neg_hi:[1,0,0]
    v_pk_mul_f32 v[104:105], v[28:29], v[238:239] op_sel:[0,1] op_sel_hi:[1,1]
    v_pk_fma_f32 v[104:105], v[28:29], v[222:223], v[104:105] op_sel:[1,1,0] op_sel_hi:[0,1,1] neg_hi:[1,0,0]
    v_pk_mul_f32 v[238:239], v[102:103], v[174:175] op_sel:[0,0] op_sel_hi:[1,0]
    v_pk_fma_f32 v[106:107], v[22:23], v[108:109], v[238:239] op_sel:[0,0,0] op_sel_hi:[0,1,1]
    v_pk_fma_f32 v[108:109], v[22:23], v[108:109], v[106:107] op_sel:[1,1,0] op_sel_hi:[1,0,1] neg_lo:[1,0,0]
    v_pk_mul_f32 v[222:223], v[104:105], v[174:175] op_sel:[0,1] op_sel_hi:[1,1]
    v_pk_fma_f32 v[106:107], v[22:23], v[108:109], v[222:223] op_sel:[0,0,0] op_sel_hi:[0,1,1]
    v_pk_fma_f32 v[108:109], v[22:23], v[108:109], v[106:107] op_sel:[1,1,0] op_sel_hi:[1,0,1] neg_lo:[1,0,0]
    v_pk_mul_f32 v[102:103], v[28:29], v[240:241] op_sel:[0,0] op_sel_hi:[1,0]
    v_pk_fma_f32 v[102:103], v[28:29], v[224:225], v[102:103] op_sel:[1,0,0] op_sel_hi:[0,0,1] neg_hi:[1,0,0]
    v_pk_mul_f32 v[104:105], v[28:29], v[240:241] op_sel:[0,1] op_sel_hi:[1,1]
    v_pk_fma_f32 v[104:105], v[28:29], v[224:225], v[104:105] op_sel:[1,1,0] op_sel_hi:[0,1,1] neg_hi:[1,0,0]
    v_pk_mul_f32 v[240:241], v[102:103], v[176:177] op_sel:[0,0] op_sel_hi:[1,0]
    v_pk_fma_f32 v[106:107], v[22:23], v[108:109], v[240:241] op_sel:[0,0,0] op_sel_hi:[0,1,1]
    buffer_load_dwordx4 v68, s[48:51], s81 offen offset:1024 lds
    v_pk_fma_f32 v[108:109], v[22:23], v[108:109], v[106:107] op_sel:[1,1,0] op_sel_hi:[1,0,1] neg_lo:[1,0,0]
    v_pk_mul_f32 v[224:225], v[104:105], v[176:177] op_sel:[0,1] op_sel_hi:[1,1]
    v_pk_fma_f32 v[106:107], v[22:23], v[108:109], v[224:225] op_sel:[0,0,0] op_sel_hi:[0,1,1]
    v_pk_fma_f32 v[108:109], v[22:23], v[108:109], v[106:107] op_sel:[1,1,0] op_sel_hi:[1,0,1] neg_lo:[1,0,0]
    v_pk_mul_f32 v[102:103], v[28:29], v[242:243] op_sel:[0,0] op_sel_hi:[1,0]
    v_pk_fma_f32 v[102:103], v[28:29], v[226:227], v[102:103] op_sel:[1,0,0] op_sel_hi:[0,0,1] neg_hi:[1,0,0]
    v_pk_mul_f32 v[104:105], v[28:29], v[242:243] op_sel:[0,1] op_sel_hi:[1,1]
    v_pk_fma_f32 v[104:105], v[28:29], v[226:227], v[104:105] op_sel:[1,1,0] op_sel_hi:[0,1,1] neg_hi:[1,0,0]
    v_pk_mul_f32 v[242:243], v[102:103], v[178:179] op_sel:[0,0] op_sel_hi:[1,0]
    v_pk_fma_f32 v[106:107], v[22:23], v[108:109], v[242:243] op_sel:[0,0,0] op_sel_hi:[0,1,1]
    v_pk_fma_f32 v[108:109], v[22:23], v[108:109], v[106:107] op_sel:[1,1,0] op_sel_hi:[1,0,1] neg_lo:[1,0,0]
    v_pk_mul_f32 v[226:227], v[104:105], v[178:179] op_sel:[0,1] op_sel_hi:[1,1]
    v_pk_fma_f32 v[106:107], v[22:23], v[108:109], v[226:227] op_sel:[0,0,0] op_sel_hi:[0,1,1]
    v_pk_fma_f32 v[108:109], v[22:23], v[108:109], v[106:107] op_sel:[1,1,0] op_sel_hi:[1,0,1] neg_lo:[1,0,0]
    v_mov_b32 v36, v108
    v_mov_b32 v37, v109
    s_lshr_b32 s82, s3, 1
    s_lshl_b32 s82, s82, 9
    v_permlane32_swap_b32 v36, v108
    v_permlane32_swap_b32 v37, v109
    s_and_b32 s83, s3, 1
    s_lshl_b32 s83, s83, 3
    s_add_u32 s82, s82, s83
    buffer_load_dwordx4 v69, s[48:51], s81 offen offset:2048 lds
    v_add_u32 v3, s82, v90
    v_pk_fma_f32 v[102:103], v[30:31], v[36:37], v[108:109] op_sel:[0,0,0] op_sel_hi:[0,1,1]
    v_pk_fma_f32 v[108:109], v[30:31], v[36:37], v[102:103] op_sel:[1,1,0] op_sel_hi:[1,0,1] neg_lo:[1,0,0]
    ds_write_b64 v3, v[108:109] offset:13312
    s_waitcnt lgkmcnt(0)
    s_waitcnt vmcnt(17)
    s_barrier
    ds_read_b128 v[102:105], v90 offset:13312
    ds_read_b128 v[106:109], v90 offset:13824
    s_waitcnt lgkmcnt(9)
    v_mfma_f32_32x32x16_bf16 v[148:163], v[60:63], a[4:7], v[148:163]
    ds_read_b64_tr_b16 v[32:33], v73 offset:0
    ds_read_b64_tr_b16 v[34:35], v73 offset:768
    ds_read_b64_tr_b16 v[48:49], v73 offset:64
    s_lshl_b32 s82, s39, 4
    v_mfma_f32_32x32x16_bf16 v[180:195], v[110:113], a[4:7], v[180:195]
    ds_read_b64_tr_b16 v[50:51], v73 offset:832
    ds_read_b64_tr_b16 v[52:53], v73 offset:128
    s_add_u32 s82, s82, s38
    s_lshl_b32 s82, s82, 9
    s_add_u32 m0, s80, 24576
    s_mov_b32 s81, 1232896
    buffer_load_dwordx4 v67, s[48:51], s81 offen offset:0 lds
    v_mfma_f32_32x32x16_bf16 v[196:211], v[248:251], v[110:113], v[196:211]
    ds_read_b64_tr_b16 v[54:55], v73 offset:896
    s_add_u32 s82, s82, 32768
    v_lshl_add_u32 v4, v7, 4, s82
    buffer_load_dwordx4 v68, s[48:51], s81 offen offset:1024 lds
    v_mfma_f32_32x32x16_bf16 v[132:147], v[114:117], a[4:7], v[132:147]
    s_lshl_b32 s82, s3, 3
    s_lshl_b32 s12, 0xff, s82
    buffer_load_dwordx4 v69, s[48:51], s81 offen offset:2048 lds
    s_waitcnt lgkmcnt(9)
    v_mfma_f32_32x32x16_bf16 v[148:163], v[118:121], a[8:11], v[148:163]
    ds_read_b64_tr_b16 v[60:61], v70 offset:12288
    ds_read_b64_tr_b16 v[62:63], v70 offset:13056
    ds_read_b64_tr_b16 v[110:111], v70 offset:12352
    s_cmp_eq_u32 s3, 1
    s_cselect_b64 s[6:7], -1, 0
    s_cmp_eq_u32 s3, 2
    s_cselect_b64 s[8:9], -1, 0
    v_mfma_f32_32x32x16_bf16 v[180:195], v[122:125], a[8:11], v[180:195]
    ds_read_b64_tr_b16 v[112:113], v70 offset:13120
    ds_read_b64_tr_b16 v[114:115], v70 offset:12416
    s_cmp_eq_u32 s3, 3
    s_cselect_b64 s[10:11], -1, 0
    s_waitcnt lgkmcnt(11)
    v_cndmask_b32 v64, 0, v102, s[6:7]
    v_mfma_f32_32x32x16_bf16 v[132:147], v[126:129], a[8:11], v[132:147]
    ds_read_b64_tr_b16 v[116:117], v70 offset:13184
    v_cndmask_b32 v65, 0, v103, s[6:7]
    v_mfma_f32_32x32x16_bf16 v[196:211], v[252:255], v[126:129], v[196:211]
    v_fmac_f32 v104, v38, v102
    v_fmac_f32 v105, v38, v103
    s_waitcnt lgkmcnt(6)
    v_mfma_f32_32x32x16_bf16 v[148:163], v[32:35], a[12:15], v[148:163]
    ds_read_b64_tr_b16 v[118:119], v71 offset:12288
    ds_read_b64_tr_b16 v[120:121], v71 offset:13056
    ds_read_b64_tr_b16 v[122:123], v71 offset:12352
    ds_read_b64_tr_b16 v[124:125], v71 offset:13120
    v_fma_f32 v104, -v39, v103, v104
    v_fmac_f32 v105, v39, v102
    v_cndmask_b32 v64, v64, v104, s[8:9]
    v_mfma_f32_32x32x16_bf16 v[180:195], v[48:51], a[12:15], v[180:195]
    ds_read_b64_tr_b16 v[126:127], v71 offset:12416
    ds_read_b64_tr_b16 v[128:129], v71 offset:13184
    v_cndmask_b32 v65, v65, v105, s[8:9]
    v_fmac_f32 v106, v38, v104
    v_fmac_f32 v107, v38, v105
    s_add_u32 m0, s78, 49152
    s_mov_b32 s81, 0
    buffer_load_dwordx4 v12, s[52:55], s81 offen offset:0 lds
    v_mfma_f32_32x32x16_bf16 v[132:147], v[52:55], a[12:15], v[132:147]
    v_fma_f32 v106, -v39, v105, v106
    v_fmac_f32 v107, v39, v104
    buffer_load_dwordx4 v13, s[52:55], s81 offen offset:1024 lds
    s_waitcnt lgkmcnt(6)
    v_mfma_f32_32x32x16_bf16 v[148:163], v[60:63], a[16:19], v[148:163]
    ds_read_b64_tr_b16 v[32:33], v72 offset:12288
    ds_read_b64_tr_b16 v[34:35], v72 offset:13056
    ds_read_b64_tr_b16 v[48:49], v72 offset:12352
    v_mov_b32 v103, s72
    v_mov_b32 v105, s72
    v_mfma_f32_32x32x16_bf16 v[196:211], v[244:247], v[60:63], v[196:211]
    ds_read_b64_tr_b16 v[50:51], v72 offset:13120
    ds_read_b64_tr_b16 v[52:53], v72 offset:12416
    v_fma_f32 v102, v38, v106, v108
    v_fma_f32 v104, v38, v107, v109
    v_fma_f32 v102, -v39, v107, v102
    v_mfma_f32_32x32x16_bf16 v[180:195], v[110:113], a[16:19], v[180:195]
    ds_read_b64_tr_b16 v[54:55], v72 offset:13184
    v_fmac_f32 v104, v39, v106
    buffer_load_dwordx4 v14, s[52:55], s81 offen offset:2048 lds
    v_mfma_f32_32x32x16_bf16 v[132:147], v[114:117], a[16:19], v[132:147]
    s_mov_b32 exec_lo, s12
    s_mov_b32 exec_hi, 0
    buffer_store_dwordx4 v[102:105], v4, s[64:67], 0 offen sc1
    s_mov_b64 exec, -1
    v_cndmask_b32 v64, v64, v106, s[10:11]
    buffer_load_dwordx4 v15, s[52:55], s81 offen offset:3072 lds
    s_waitcnt lgkmcnt(6)
    v_mfma_f32_32x32x16_bf16 v[148:163], v[118:121], a[20:23], v[148:163]
    ds_read_b64_tr_b16 v[60:61], v73 offset:12288
    ds_read_b64_tr_b16 v[62:63], v73 offset:13056
    ds_read_b64_tr_b16 v[110:111], v73 offset:12352
    v_cndmask_b32 v65, v65, v107, s[10:11]
    v_cmp_gt_u32 vcc, 32, v0
    v_mfma_f32_32x32x16_bf16 v[180:195], v[122:125], a[20:23], v[180:195]
    ds_read_b64_tr_b16 v[112:113], v73 offset:13120
    ds_read_b64_tr_b16 v[114:115], v73 offset:12416
    v_fmac_f32 v36, v30, v64
    v_fmac_f32 v37, v30, v65
    v_fma_f32 v36, -v31, v65, v36
    v_mfma_f32_32x32x16_bf16 v[196:211], v[248:251], v[122:125], v[196:211]
    ds_read_b64_tr_b16 v[116:117], v73 offset:13184
    v_fmac_f32 v37, v31, v64
    s_add_u32 m0, s78, 65536
    s_mov_b32 s81, 32768
    buffer_load_dwordx4 v12, s[52:55], s81 offen offset:0 lds
    v_mfma_f32_32x32x16_bf16 v[132:147], v[126:129], a[20:23], v[132:147]
    v_cndmask_b32 v64, v36, v64, vcc
    v_cndmask_b32 v65, v37, v65, vcc
    buffer_load_dwordx4 v13, s[52:55], s81 offen offset:1024 lds
    s_waitcnt vmcnt(22)
    s_barrier
    s_waitcnt lgkmcnt(6)
    v_mfma_f32_32x32x16_bf16 v[148:163], v[32:35], a[24:27], v[148:163]
    ds_read_b64_tr_b16 v[118:119], v70 offset:24576
    ds_read_b64_tr_b16 v[120:121], v70 offset:25344
    ds_read_b64_tr_b16 v[122:123], v70 offset:24640
    v_mfma_f32_32x32x16_bf16 v[180:195], v[48:51], a[24:27], v[180:195]
    ds_read_b64_tr_b16 v[124:125], v70 offset:25408
    ds_read_b64_tr_b16 v[126:127], v70 offset:24704
    v_mfma_f32_32x32x16_bf16 v[132:147], v[52:55], a[24:27], v[132:147]
    ds_read_b64_tr_b16 v[128:129], v70 offset:25472
    buffer_load_dwordx4 v14, s[52:55], s81 offen offset:2048 lds
    v_mfma_f32_32x32x16_bf16 v[196:211], v[252:255], v[52:55], v[196:211]
    buffer_load_dwordx4 v15, s[52:55], s81 offen offset:3072 lds
    s_waitcnt lgkmcnt(6)
    v_mfma_f32_32x32x16_bf16 v[148:163], v[60:63], a[28:31], v[148:163]
    ds_read_b64_tr_b16 v[32:33], v71 offset:24576
    ds_read_b64_tr_b16 v[34:35], v71 offset:25344
    ds_read_b64_tr_b16 v[48:49], v71 offset:24640
    ds_read_b64_tr_b16 v[50:51], v71 offset:25408
    v_mfma_f32_32x32x16_bf16 v[180:195], v[110:113], a[28:31], v[180:195]
    ds_read_b64_tr_b16 v[52:53], v71 offset:24704
    ds_read_b64_tr_b16 v[54:55], v71 offset:25472
    s_add_u32 m0, s78, 81920
    s_mov_b32 s81, 0
    buffer_load_dwordx4 v12, s[56:59], s81 offen offset:0 lds
    v_mfma_f32_32x32x16_bf16 v[132:147], v[114:117], a[28:31], v[132:147]
    buffer_load_dwordx4 v13, s[56:59], s81 offen offset:1024 lds
    s_waitcnt lgkmcnt(6)
    v_mfma_f32_32x32x16_bf16 v[148:163], v[118:121], a[32:35], v[148:163]
    ds_read_b64_tr_b16 v[60:61], v72 offset:24576
    ds_read_b64_tr_b16 v[62:63], v72 offset:25344
    ds_read_b64_tr_b16 v[110:111], v72 offset:24640
    v_mfma_f32_32x32x16_bf16 v[196:211], v[244:247], v[118:121], v[196:211]
    ds_read_b64_tr_b16 v[112:113], v72 offset:25408
    ds_read_b64_tr_b16 v[114:115], v72 offset:24704
    v_mfma_f32_32x32x16_bf16 v[180:195], v[122:125], a[32:35], v[180:195]
    ds_read_b64_tr_b16 v[116:117], v72 offset:25472
    v_mfma_f32_32x32x16_bf16 v[132:147], v[126:129], a[32:35], v[132:147]
    buffer_load_dwordx4 v14, s[56:59], s81 offen offset:2048 lds
    s_waitcnt lgkmcnt(6)
    v_mfma_f32_32x32x16_bf16 v[148:163], v[32:35], a[36:39], v[148:163]
    ds_read_b64_tr_b16 v[118:119], v73 offset:24576
    ds_read_b64_tr_b16 v[120:121], v73 offset:25344
    ds_read_b64_tr_b16 v[122:123], v73 offset:24640
    v_mfma_f32_32x32x16_bf16 v[180:195], v[48:51], a[36:39], v[180:195]
    ds_read_b64_tr_b16 v[124:125], v73 offset:25408
    ds_read_b64_tr_b16 v[126:127], v73 offset:24704
    v_mfma_f32_32x32x16_bf16 v[196:211], v[248:251], v[48:51], v[196:211]
    ds_read_b64_tr_b16 v[128:129], v73 offset:25472
    v_mfma_f32_32x32x16_bf16 v[132:147], v[52:55], a[36:39], v[132:147]
    buffer_load_dwordx4 v15, s[56:59], s81 offen offset:3072 lds
    s_waitcnt vmcnt(25)
    s_barrier
    s_waitcnt lgkmcnt(6)
    v_mfma_f32_32x32x16_bf16 v[148:163], v[60:63], a[40:43], v[148:163]
    ds_read_b64_tr_b16 v[32:33], v70 offset:36864
    ds_read_b64_tr_b16 v[34:35], v70 offset:37632
    ds_read_b64_tr_b16 v[48:49], v70 offset:36928
    v_mfma_f32_32x32x16_bf16 v[180:195], v[110:113], a[40:43], v[180:195]
    ds_read_b64_tr_b16 v[50:51], v70 offset:37696
    ds_read_b64_tr_b16 v[52:53], v70 offset:36992
    s_waitcnt vmcnt(8)
    ds_read_b128 a[128:131], v20 offset:0
    ds_read_b128 a[132:135], v20 offset:2048
    v_mfma_f32_32x32x16_bf16 v[132:147], v[114:117], a[40:43], v[132:147]
    ds_read_b64_tr_b16 v[54:55], v70 offset:37760
    ds_read_b128 a[160:163], v21 offset:0
    ds_read_b128 a[164:167], v21 offset:2048
    v_mfma_f32_32x32x16_bf16 v[196:211], v[252:255], v[114:117], v[196:211]
    s_add_u32 m0, s78, 98304
    s_mov_b32 s81, 0
    buffer_load_dwordx4 v76, s[60:63], s81 offen offset:0 lds
    buffer_load_dwordx4 v77, s[60:63], s81 offen offset:1024 lds
    s_waitcnt lgkmcnt(10)
    v_mfma_f32_32x32x16_bf16 v[148:163], v[118:121], a[44:47], v[148:163]
    ds_read_b64_tr_b16 v[60:61], v71 offset:36864
    ds_read_b64_tr_b16 v[62:63], v71 offset:37632
    ds_read_b64_tr_b16 v[110:111], v71 offset:36928
    ds_read_b64_tr_b16 v[112:113], v71 offset:37696
    v_mfma_f32_32x32x16_bf16 v[180:195], v[122:125], a[44:47], v[180:195]
    ds_read_b64_tr_b16 v[114:115], v71 offset:36992
    ds_read_b64_tr_b16 v[116:117], v71 offset:37760
    buffer_load_dwordx4 v78, s[60:63], s81 offen offset:2048 lds
    v_mfma_f32_32x32x16_bf16 v[132:147], v[126:129], a[44:47], v[132:147]
    buffer_load_dwordx4 v79, s[60:63], s81 offen offset:3072 lds
    s_waitcnt lgkmcnt(8)
    v_mfma_f32_32x32x16_bf16 v[148:163], v[32:35], a[48:51], v[148:163]
    ds_read_b64_tr_b16 v[118:119], v72 offset:36864
    ds_read_b64_tr_b16 v[120:121], v72 offset:37632
    ds_read_b64_tr_b16 v[122:123], v72 offset:36928
    v_mfma_f32_32x32x16_bf16 v[196:211], v[244:247], v[32:35], v[196:211]
    ds_read_b64_tr_b16 v[124:125], v72 offset:37696
    ds_read_b64_tr_b16 v[126:127], v72 offset:36992
    s_waitcnt vmcnt(8)
    ds_read_b128 a[136:139], v20 offset:16384
    ds_read_b128 a[140:143], v20 offset:18432
    v_mfma_f32_32x32x16_bf16 v[180:195], v[48:51], a[48:51], v[180:195]
    ds_read_b64_tr_b16 v[128:129], v72 offset:37760
    ds_read_b128 a[168:171], v21 offset:16384
    ds_read_b128 a[172:175], v21 offset:18432
    s_waitcnt lgkmcnt(15)
    v_mfma_f32_32x32x16_bf16 v[132:147], v[52:55], a[48:51], v[132:147]
    s_add_u32 m0, s78, 49152
    s_mov_b32 s81, 32768
    buffer_load_dwordx4 v12, s[56:59], s81 offen offset:0 lds
    buffer_load_dwordx4 v13, s[56:59], s81 offen offset:1024 lds
    s_waitcnt lgkmcnt(10)
    v_mfma_f32_32x32x16_bf16 v[148:163], v[60:63], a[52:55], v[148:163]
    ds_read_b64_tr_b16 v[32:33], v73 offset:36864
    ds_read_b64_tr_b16 v[34:35], v73 offset:37632
    ds_read_b64_tr_b16 v[48:49], v73 offset:36928
    v_mfma_f32_32x32x16_bf16 v[180:195], v[110:113], a[52:55], v[180:195]
    ds_read_b64_tr_b16 v[50:51], v73 offset:37696
    ds_read_b64_tr_b16 v[52:53], v73 offset:36992
    buffer_load_dwordx4 v[164:167], v91, s[64:67], 0 offen sc1
    v_mfma_f32_32x32x16_bf16 v[196:211], v[248:251], v[110:113], v[196:211]
    ds_read_b64_tr_b16 v[54:55], v73 offset:37760
    buffer_load_dwordx4 v[168:171], v92, s[64:67], 0 offen offset:512 sc1
    buffer_load_dwordx4 v14, s[56:59], s81 offen offset:2048 lds
    v_mfma_f32_32x32x16_bf16 v[132:147], v[114:117], a[52:55], v[132:147]
    buffer_load_dwordx4 v15, s[56:59], s81 offen offset:3072 lds
    s_waitcnt vmcnt(32)
    s_barrier
    s_waitcnt lgkmcnt(8)
    v_mfma_f32_32x32x16_bf16 v[148:163], v[118:121], a[56:59], v[148:163]
    ds_read_b64_tr_b16 v[60:61], v70 offset:49152
    ds_read_b64_tr_b16 v[62:63], v70 offset:49920
    ds_read_b64_tr_b16 v[110:111], v70 offset:49216
    v_mfma_f32_32x32x16_bf16 v[180:195], v[122:125], a[56:59], v[180:195]
    ds_read_b64_tr_b16 v[112:113], v70 offset:49984
    ds_read_b64_tr_b16 v[114:115], v70 offset:49280
    s_waitcnt lgkmcnt(11)
    v_mfma_f32_32x32x16_bf16 v[132:147], v[126:129], a[56:59], v[132:147]
    ds_read_b64_tr_b16 v[116:117], v70 offset:50048
    s_add_u32 m0, s78, 65536
    s_mov_b32 s81, 128
    buffer_load_dwordx4 v12, s[52:55], s81 offen offset:0 lds
    v_mfma_f32_32x32x16_bf16 v[196:211], v[252:255], v[126:129], v[196:211]
    buffer_load_dwordx4 v13, s[52:55], s81 offen offset:1024 lds
    s_waitcnt lgkmcnt(6)
    v_mfma_f32_32x32x16_bf16 v[148:163], v[32:35], a[60:63], v[148:163]
    ds_read_b64_tr_b16 v[118:119], v71 offset:49152
    ds_read_b64_tr_b16 v[120:121], v71 offset:49920
    ds_read_b64_tr_b16 v[122:123], v71 offset:49216
    ds_read_b64_tr_b16 v[124:125], v71 offset:49984
    s_waitcnt vmcnt(12)
    v_mfma_f32_32x32x16_bf16 v[180:195], v[48:51], a[60:63], v[180:195]
    ds_read_b64_tr_b16 v[126:127], v71 offset:49280
    ds_read_b64_tr_b16 v[128:129], v71 offset:50048
    ds_read_b128 a[144:147], v20 offset:32768
    ds_read_b128 a[148:151], v20 offset:34816
    ds_read_b128 a[176:179], v21 offset:32768
    ds_read_b128 a[180:183], v21 offset:34816
    v_mfma_f32_32x32x16_bf16 v[132:147], v[52:55], a[60:63], v[132:147]
    buffer_load_dwordx4 v14, s[52:55], s81 offen offset:2048 lds
    buffer_load_dwordx4 v15, s[52:55], s81 offen offset:3072 lds
    s_waitcnt lgkmcnt(10)
    v_mfma_f32_32x32x16_bf16 v[148:163], v[60:63], a[64:67], v[148:163]
    ds_read_b64_tr_b16 v[32:33], v72 offset:49152
    ds_read_b64_tr_b16 v[34:35], v72 offset:49920
    ds_read_b64_tr_b16 v[48:49], v72 offset:49216
    v_mfma_f32_32x32x16_bf16 v[196:211], v[244:247], v[60:63], v[196:211]
    ds_read_b64_tr_b16 v[50:51], v72 offset:49984
    ds_read_b64_tr_b16 v[52:53], v72 offset:49280
    s_add_u32 m0, s78, 114688
    s_mov_b32 s81, 32768
    buffer_load_dwordx4 v76, s[60:63], s81 offen offset:0 lds
    v_mfma_f32_32x32x16_bf16 v[180:195], v[110:113], a[64:67], v[180:195]
    ds_read_b64_tr_b16 v[54:55], v72 offset:50048
    buffer_load_dwordx4 v77, s[60:63], s81 offen offset:1024 lds
    buffer_load_dwordx4 v78, s[60:63], s81 offen offset:2048 lds
    v_mfma_f32_32x32x16_bf16 v[132:147], v[114:117], a[64:67], v[132:147]
    buffer_load_dwordx4 v79, s[60:63], s81 offen offset:3072 lds
    s_waitcnt lgkmcnt(10)
    v_mfma_f32_32x32x16_bf16 v[148:163], v[118:121], a[68:71], v[148:163]
    ds_read_b64_tr_b16 v[60:61], v73 offset:49152
    ds_read_b64_tr_b16 v[62:63], v73 offset:49920
    ds_read_b64_tr_b16 v[110:111], v73 offset:49216
    v_mfma_f32_32x32x16_bf16 v[180:195], v[122:125], a[68:71], v[180:195]
    ds_read_b64_tr_b16 v[112:113], v73 offset:49984
    ds_read_b64_tr_b16 v[114:115], v73 offset:49280
    s_waitcnt lgkmcnt(11)
    v_mfma_f32_32x32x16_bf16 v[196:211], v[248:251], v[122:125], v[196:211]
    ds_read_b64_tr_b16 v[116:117], v73 offset:50048
    s_add_u32 m0, s78, 81920
    s_mov_b32 s81, 32896
    buffer_load_dwordx4 v12, s[52:55], s81 offen offset:0 lds
    v_mfma_f32_32x32x16_bf16 v[132:147], v[126:129], a[68:71], v[132:147]
    buffer_load_dwordx4 v13, s[52:55], s81 offen offset:1024 lds
    s_waitcnt vmcnt(39)
    s_barrier
    s_waitcnt lgkmcnt(6)
    v_mfma_f32_32x32x16_bf16 v[148:163], v[32:35], a[72:75], v[148:163]
    v_subrev_u32 v70, 98304, v70
    v_subrev_u32 v71, 98304, v71
    v_subrev_u32 v72, 98304, v72
    v_subrev_u32 v73, 98304, v73
    ds_read_b64_tr_b16 v[118:119], v70 offset:0
    v_mfma_f32_32x32x16_bf16 v[180:195], v[48:51], a[72:75], v[180:195]
    ds_read_b64_tr_b16 v[120:121], v70 offset:768
    ds_read_b64_tr_b16 v[122:123], v70 offset:64
    ds_read_b64_tr_b16 v[124:125], v70 offset:832
    s_waitcnt vmcnt(10)
    ds_read_b128 a[152:155], v20 offset:0
    ds_read_b128 a[156:159], v20 offset:2048
    v_mfma_f32_32x32x16_bf16 v[132:147], v[52:55], a[72:75], v[132:147]
    ds_read_b64_tr_b16 v[126:127], v70 offset:128
    ds_read_b64_tr_b16 v[128:129], v70 offset:896
    ds_read_b128 a[184:187], v21 offset:0
    ds_read_b128 a[188:191], v21 offset:2048
    v_mfma_f32_32x32x16_bf16 v[196:211], v[252:255], v[52:55], v[196:211]
    buffer_load_dwordx4 v14, s[52:55], s81 offen offset:2048 lds
    buffer_load_dwordx4 v15, s[52:55], s81 offen offset:3072 lds
    s_waitcnt lgkmcnt(10)
    v_mfma_f32_32x32x16_bf16 v[148:163], v[60:63], a[76:79], v[148:163]
    ds_read_b64_tr_b16 v[32:33], v71 offset:0
    ds_read_b64_tr_b16 v[34:35], v71 offset:768
    ds_read_b64_tr_b16 v[48:49], v71 offset:64
    ds_read_b64_tr_b16 v[50:51], v71 offset:832
    s_waitcnt vmcnt(14)
    v_cmp_ne_u32 s[6:7], s72, v165
    v_mfma_f32_32x32x16_bf16 v[180:195], v[110:113], a[76:79], v[180:195]
    ds_read_b64_tr_b16 v[52:53], v71 offset:128
    ds_read_b64_tr_b16 v[54:55], v71 offset:896
    v_cmp_ne_u32 s[8:9], s72, v167
    v_cmp_ne_u32 s[10:11], s72, v169
    v_cmp_ne_u32 s[12:13], s72, v171
    s_waitcnt lgkmcnt(6)
    s_add_u32 m0, s78, 49152
    s_mov_b32 s81, 128
    buffer_load_dwordx4 v12, s[56:59], s81 offen offset:0 lds
    v_mfma_f32_32x32x16_bf16 v[132:147], v[114:117], a[76:79], v[132:147]
    s_or_b64 s[6:7], s[6:7], s[8:9]
    buffer_load_dwordx4 v13, s[56:59], s81 offen offset:1024 lds
    s_waitcnt lgkmcnt(8)
    v_mfma_f32_32x32x16_bf16 v[148:163], v[118:121], a[80:83], v[148:163]
    ds_read_b64_tr_b16 v[60:61], v72 offset:0
    ds_read_b64_tr_b16 v[62:63], v72 offset:768
    ds_read_b64_tr_b16 v[110:111], v72 offset:64
    s_and_b64 s[6:7], s[6:7], s[90:91]
    s_or_b64 s[10:11], s[10:11], s[12:13]
    v_mfma_f32_32x32x16_bf16 v[196:211], v[244:247], v[118:121], v[196:211]
    ds_read_b64_tr_b16 v[112:113], v72 offset:832
    ds_read_b64_tr_b16 v[114:115], v72 offset:128
    s_and_b64 s[10:11], s[10:11], s[92:93]
    v_mfma_f32_32x32x16_bf16 v[180:195], v[122:125], a[80:83], v[180:195]
    ds_read_b64_tr_b16 v[116:117], v72 offset:896
    s_or_b64 s[6:7], s[6:7], s[10:11]
    s_cbranch_scc1 L_slow_cg
L_back_cg:
    v_mul_f32 v102, v42, v164
    buffer_load_dwordx4 v14, s[56:59], s81 offen offset:2048 lds
    v_mfma_f32_32x32x16_bf16 v[132:147], v[126:129], a[80:83], v[132:147]
    v_mul_f32 v103, v42, v166
    buffer_load_dwordx4 v15, s[56:59], s81 offen offset:3072 lds
    s_waitcnt lgkmcnt(6)
    v_mfma_f32_32x32x16_bf16 v[148:163], v[32:35], a[84:87], v[148:163]
    ds_read_b64_tr_b16 v[118:119], v73 offset:0
    ds_read_b64_tr_b16 v[120:121], v73 offset:768
    ds_read_b64_tr_b16 v[122:123], v73 offset:64
    v_fma_f32 v102, -v43, v166, v102
    v_fmac_f32 v103, v43, v164
    v_mfma_f32_32x32x16_bf16 v[180:195], v[48:51], a[84:87], v[180:195]
    ds_read_b64_tr_b16 v[124:125], v73 offset:832
    ds_read_b64_tr_b16 v[126:127], v73 offset:128
    v_fmac_f32 v102, v44, v168
    v_fmac_f32 v103, v44, v170
    s_waitcnt vmcnt(12)
    ds_read_b128 a[192:195], v20 offset:16384
    ds_read_b128 a[196:199], v20 offset:18432
    v_mfma_f32_32x32x16_bf16 v[196:211], v[248:251], v[48:51], v[196:211]
    ds_read_b64_tr_b16 v[128:129], v73 offset:896
    v_fma_f32 v102, -v45, v170, v102
    v_fmac_f32 v103, v45, v168
    ds_read_b128 a[224:227], v21 offset:16384
    ds_read_b128 a[228:231], v21 offset:18432
    v_mfma_f32_32x32x16_bf16 v[132:147], v[52:55], a[84:87], v[132:147]
    ds_write_b64 v89, v[102:103] offset:13312
    s_add_u32 m0, s78, 131072
    s_mov_b32 s81, 65536
    buffer_load_dwordx4 v76, s[60:63], s81 offen offset:0 lds
    buffer_load_dwordx4 v77, s[60:63], s81 offen offset:1024 lds
    s_waitcnt vmcnt(44) lgkmcnt(0)
    s_barrier
    ds_read_b128 v[164:167], v90 offset:13312
    ds_read_b128 v[168:171], v90 offset:13824
    ds_read_b128 v[172:175], v90 offset:14336
    ds_read_b128 v[176:179], v90 offset:14848
    s_waitcnt lgkmcnt(15)
    v_mfma_f32_32x32x16_bf16 v[148:163], v[60:63], a[88:91], v[148:163]
    ds_read_b64_tr_b16 v[32:33], v70 offset:12288
    ds_read_b64_tr_b16 v[34:35], v70 offset:13056
    ds_read_b64_tr_b16 v[48:49], v70 offset:12352
    v_mfma_f32_32x32x16_bf16 v[180:195], v[110:113], a[88:91], v[180:195]
    ds_read_b64_tr_b16 v[50:51], v70 offset:13120
    ds_read_b64_tr_b16 v[52:53], v70 offset:12416
    v_mfma_f32_32x32x16_bf16 v[132:147], v[114:117], a[88:91], v[132:147]
    ds_read_b64_tr_b16 v[54:55], v70 offset:13184
    buffer_load_dwordx4 v78, s[60:63], s81 offen offset:2048 lds
    v_mfma_f32_32x32x16_bf16 v[196:211], v[252:255], v[114:117], v[196:211]
    buffer_load_dwordx4 v79, s[60:63], s81 offen offset:3072 lds
    s_waitcnt lgkmcnt(6)
    v_pk_add_f32 v[164:165], v[164:165], v[166:167]
    v_pk_add_f32 v[168:169], v[168:169], v[170:171]
    v_pk_add_f32 v[172:173], v[172:173], v[174:175]
    v_pk_add_f32 v[176:177], v[176:177], v[178:179]
    v_pk_add_f32 v[164:165], v[164:165], v[168:169]
    v_pk_add_f32 v[172:173], v[172:173], v[176:177]
    v_pk_add_f32 v[164:165], v[164:165], v[172:173]
    v_pk_fma_f32 v[102:103], v[40:41], v[164:165], v[64:65] op_sel:[0,0,0] op_sel_hi:[0,1,1]
    v_pk_fma_f32 v[64:65], v[40:41], v[164:165], v[102:103] op_sel:[1,1,0] op_sel_hi:[1,0,1] neg_lo:[1,0,0]
    v_pk_fma_f32 v[102:103], v[22:23], v[64:65], v[228:229] op_sel:[0,0,0] op_sel_hi:[0,1,1]
    v_pk_fma_f32 v[228:229], v[22:23], v[64:65], v[102:103] op_sel:[1,1,0] op_sel_hi:[1,0,1] neg_lo:[1,0,0]
    v_pk_fma_f32 v[102:103], v[22:23], v[228:229], v[212:213] op_sel:[0,0,0] op_sel_hi:[0,1,1]
    v_pk_fma_f32 v[212:213], v[22:23], v[228:229], v[102:103] op_sel:[1,1,0] op_sel_hi:[1,0,1] neg_lo:[1,0,0]
    v_cvt_pk_bf16_f32 v164, v228, v212
    v_cvt_pk_bf16_f32 v172, v229, v213
    v_pk_fma_f32 v[102:103], v[22:23], v[212:213], v[230:231] op_sel:[0,0,0] op_sel_hi:[0,1,1]
    v_pk_fma_f32 v[230:231], v[22:23], v[212:213], v[102:103] op_sel:[1,1,0] op_sel_hi:[1,0,1] neg_lo:[1,0,0]
    v_pk_fma_f32 v[102:103], v[22:23], v[230:231], v[214:215] op_sel:[0,0,0] op_sel_hi:[0,1,1]
    v_pk_fma_f32 v[214:215], v[22:23], v[230:231], v[102:103] op_sel:[1,1,0] op_sel_hi:[1,0,1] neg_lo:[1,0,0]
    v_cvt_pk_bf16_f32 v165, v230, v214
    v_cvt_pk_bf16_f32 v173, v231, v215
    v_pk_fma_f32 v[102:103], v[22:23], v[214:215], v[232:233] op_sel:[0,0,0] op_sel_hi:[0,1,1]
    v_pk_fma_f32 v[232:233], v[22:23], v[214:215], v[102:103] op_sel:[1,1,0] op_sel_hi:[1,0,1] neg_lo:[1,0,0]
    v_pk_fma_f32 v[102:103], v[22:23], v[232:233], v[216:217] op_sel:[0,0,0] op_sel_hi:[0,1,1]
    v_pk_fma_f32 v[216:217], v[22:23], v[232:233], v[102:103] op_sel:[1,1,0] op_sel_hi:[1,0,1] neg_lo:[1,0,0]
    v_cvt_pk_bf16_f32 v166, v232, v216
    v_cvt_pk_bf16_f32 v174, v233, v217
    v_pk_fma_f32 v[102:103], v[22:23], v[216:217], v[234:235] op_sel:[0,0,0] op_sel_hi:[0,1,1]
    v_pk_fma_f32 v[234:235], v[22:23], v[216:217], v[102:103] op_sel:[1,1,0] op_sel_hi:[1,0,1] neg_lo:[1,0,0]
    v_pk_fma_f32 v[102:103], v[22:23], v[234:235], v[218:219] op_sel:[0,0,0] op_sel_hi:[0,1,1]
    v_pk_fma_f32 v[218:219], v[22:23], v[234:235], v[102:103] op_sel:[1,1,0] op_sel_hi:[1,0,1] neg_lo:[1,0,0]
    v_cvt_pk_bf16_f32 v167, v234, v218
    v_cvt_pk_bf16_f32 v175, v235, v219
    v_pk_fma_f32 v[102:103], v[22:23], v[218:219], v[236:237] op_sel:[0,0,0] op_sel_hi:[0,1,1]
    v_pk_fma_f32 v[236:237], v[22:23], v[218:219], v[102:103] op_sel:[1,1,0] op_sel_hi:[1,0,1] neg_lo:[1,0,0]
    v_pk_fma_f32 v[102:103], v[22:23], v[236:237], v[220:221] op_sel:[0,0,0] op_sel_hi:[0,1,1]
    v_pk_fma_f32 v[220:221], v[22:23], v[236:237], v[102:103] op_sel:[1,1,0] op_sel_hi:[1,0,1] neg_lo:[1,0,0]
    v_cvt_pk_bf16_f32 v168, v236, v220
    v_cvt_pk_bf16_f32 v176, v237, v221
    v_pk_fma_f32 v[102:103], v[22:23], v[220:221], v[238:239] op_sel:[0,0,0] op_sel_hi:[0,1,1]
    v_pk_fma_f32 v[238:239], v[22:23], v[220:221], v[102:103] op_sel:[1,1,0] op_sel_hi:[1,0,1] neg_lo:[1,0,0]
    v_pk_fma_f32 v[102:103], v[22:23], v[238:239], v[222:223] op_sel:[0,0,0] op_sel_hi:[0,1,1]
    v_pk_fma_f32 v[222:223], v[22:23], v[238:239], v[102:103] op_sel:[1,1,0] op_sel_hi:[1,0,1] neg_lo:[1,0,0]
    v_cvt_pk_bf16_f32 v169, v238, v222
    v_cvt_pk_bf16_f32 v177, v239, v223
    v_pk_fma_f32 v[102:103], v[22:23], v[222:223], v[240:241] op_sel:[0,0,0] op_sel_hi:[0,1,1]
    v_pk_fma_f32 v[240:241], v[22:23], v[222:223], v[102:103] op_sel:[1,1,0] op_sel_hi:[1,0,1] neg_lo:[1,0,0]
    v_pk_fma_f32 v[102:103], v[22:23], v[240:241], v[224:225] op_sel:[0,0,0] op_sel_hi:[0,1,1]
    v_pk_fma_f32 v[224:225], v[22:23], v[240:241], v[102:103] op_sel:[1,1,0] op_sel_hi:[1,0,1] neg_lo:[1,0,0]
    v_cvt_pk_bf16_f32 v170, v240, v224
    v_cvt_pk_bf16_f32 v178, v241, v225
    v_pk_fma_f32 v[102:103], v[22:23], v[224:225], v[242:243] op_sel:[0,0,0] op_sel_hi:[0,1,1]
    v_pk_fma_f32 v[242:243], v[22:23], v[224:225], v[102:103] op_sel:[1,1,0] op_sel_hi:[1,0,1] neg_lo:[1,0,0]
    v_pk_fma_f32 v[102:103], v[22:23], v[242:243], v[226:227] op_sel:[0,0,0] op_sel_hi:[0,1,1]
    v_pk_fma_f32 v[226:227], v[22:23], v[242:243], v[102:103] op_sel:[1,1,0] op_sel_hi:[1,0,1] neg_lo:[1,0,0]
    v_cvt_pk_bf16_f32 v171, v242, v226
    v_cvt_pk_bf16_f32 v179, v243, v227
    s_waitcnt lgkmcnt(13)
    v_mfma_f32_32x32x16_bf16 v[148:163], v[118:121], a[92:95], v[148:163]
    ds_read_b64_tr_b16 v[60:61], v71 offset:12288
    ds_read_b64_tr_b16 v[62:63], v71 offset:13056
    ds_read_b64_tr_b16 v[110:111], v71 offset:12352
    ds_read_b64_tr_b16 v[112:113], v71 offset:13120
    ds_write_b128 v83, v[164:167]
    ds_write_b128 v83, v[168:171] offset:16
    v_mfma_f32_32x32x16_bf16 v[180:195], v[122:125], a[92:95], v[180:195]
    ds_read_b64_tr_b16 v[114:115], v71 offset:12416
    ds_read_b64_tr_b16 v[116:117], v71 offset:13184
    ds_read_b64_tr_b16 v[228:229], v84 offset:0
    ds_read_b64_tr_b16 v[230:231], v84 offset:320
    ds_read_b64_tr_b16 v[232:233], v84 offset:16
    s_waitcnt lgkmcnt(15)
    s_add_u32 m0, s78, 65536
    s_mov_b32 s81, 32896
    buffer_load_dwordx4 v12, s[56:59], s81 offen offset:0 lds
    v_mfma_f32_32x32x16_bf16 v[132:147], v[126:129], a[92:95], v[132:147]
    ds_read_b64_tr_b16 v[234:235], v84 offset:336
    buffer_load_dwordx4 v13, s[56:59], s81 offen offset:1024 lds
    s_waitcnt lgkmcnt(12)
    v_mfma_f32_32x32x16_bf16 v[148:163], v[32:35], a[96:99], v[148:163]
    ds_read_b64_tr_b16 v[118:119], v72 offset:12288
    ds_read_b64_tr_b16 v[120:121], v72 offset:13056
    ds_read_b64_tr_b16 v[122:123], v72 offset:12352
    ds_write_b128 v83, v[172:175]
    ds_write_b128 v83, v[176:179] offset:16
    v_mfma_f32_32x32x16_bf16 v[196:211], v[244:247], v[32:35], v[196:211]
    ds_read_b64_tr_b16 v[124:125], v72 offset:13120
    ds_read_b64_tr_b16 v[126:127], v72 offset:12416
    ds_read_b64_tr_b16 v[236:237], v84 offset:0
    s_waitcnt vmcnt(10)
    ds_read_b128 a[200:203], v20 offset:32768
    ds_read_b128 a[204:207], v20 offset:34816
    v_mfma_f32_32x32x16_bf16 v[180:195], v[48:51], a[96:99], v[180:195]
    ds_read_b64_tr_b16 v[128:129], v72 offset:13184
    ds_read_b64_tr_b16 v[238:239], v84 offset:320
    ds_read_b64_tr_b16 v[240:241], v84 offset:16
    ds_read_b128 a[232:235], v21 offset:32768
    ds_read_b128 a[236:239], v21 offset:34816
    v_mfma_f32_32x32x16_bf16 v[132:147], v[52:55], a[96:99], v[132:147]
    ds_read_b64_tr_b16 v[242:243], v84 offset:336
    buffer_load_dwordx4 v14, s[56:59], s81 offen offset:2048 lds
    buffer_load_dwordx4 v15, s[56:59], s81 offen offset:3072 lds
    s_waitcnt lgkmcnt(15)
    v_mfma_f32_32x32x16_bf16 v[148:163], v[60:63], a[100:103], v[148:163]
    ds_read_b64_tr_b16 v[32:33], v73 offset:12288
    ds_read_b64_tr_b16 v[34:35], v73 offset:13056
    ds_read_b64_tr_b16 v[48:49], v73 offset:12352
    v_mfma_f32_32x32x16_bf16 v[180:195], v[110:113], a[100:103], v[180:195]
    ds_read_b64_tr_b16 v[50:51], v73 offset:13120
    ds_read_b64_tr_b16 v[52:53], v73 offset:12416
    v_mfma_f32_32x32x16_bf16 v[196:211], v[248:251], v[110:113], v[196:211]
    ds_read_b64_tr_b16 v[54:55], v73 offset:13184
    s_waitcnt lgkmcnt(7)
    v_mfma_f32_32x32x16_bf16 v[132:147], v[114:117], a[100:103], v[132:147]
    s_add_u32 m0, s78, 81920
    s_mov_b32 s81, 98304
    buffer_load_dwordx4 v76, s[60:63], s81 offen offset:0 lds
    s_waitcnt vmcnt(48)
    s_barrier
    s_waitcnt lgkmcnt(11)
    v_mfma_f32_32x32x16_bf16 v[148:163], v[118:121], a[104:107], v[148:163]
    ds_read_b64_tr_b16 v[60:61], v70 offset:24576
    ds_read_b64_tr_b16 v[62:63], v70 offset:25344
    ds_read_b64_tr_b16 v[110:111], v70 offset:24640
    v_mfma_f32_32x32x16_bf16 v[180:195], v[122:125], a[104:107], v[180:195]
    ds_read_b64_tr_b16 v[112:113], v70 offset:25408
    ds_read_b64_tr_b16 v[114:115], v70 offset:24704
    s_waitcnt vmcnt(9)
    ds_read_b128 a[208:211], v20 offset:0
    v_mfma_f32_32x32x16_bf16 v[132:147], v[126:129], a[104:107], v[132:147]
    ds_read_b64_tr_b16 v[116:117], v70 offset:25472
    ds_read_b128 a[212:215], v20 offset:2048
    ds_read_b128 a[240:243], v21 offset:0
    v_mfma_f32_32x32x16_bf16 v[196:211], v[252:255], v[126:129], v[196:211]
    ds_read_b128 a[244:247], v21 offset:2048
    buffer_load_dwordx4 v77, s[60:63], s81 offen offset:1024 lds
    s_waitcnt lgkmcnt(10)
    v_mfma_f32_32x32x16_bf16 v[148:163], v[32:35], a[108:111], v[148:163]
    ds_read_b64_tr_b16 v[118:119], v71 offset:24576
    ds_read_b64_tr_b16 v[120:121], v71 offset:25344
    ds_read_b64_tr_b16 v[122:123], v71 offset:24640
    ds_read_b64_tr_b16 v[124:125], v71 offset:25408
    v_mfma_f32_32x32x16_bf16 v[180:195], v[48:51], a[108:111], v[180:195]
    ds_read_b64_tr_b16 v[126:127], v71 offset:24704
    ds_read_b64_tr_b16 v[128:129], v71 offset:25472
    s_waitcnt lgkmcnt(15)
    v_mfma_f32_32x32x16_bf16 v[132:147], v[52:55], a[108:111], v[132:147]
    buffer_store_dwordx4 v[228:231], v85, s[64:67], 0 offen offset:0 sc1
    buffer_load_dwordx4 v78, s[60:63], s81 offen offset:2048 lds
    s_waitcnt lgkmcnt(9)
    v_mfma_f32_32x32x16_bf16 v[148:163], v[60:63], a[112:115], v[148:163]
    ds_read_b64_tr_b16 v[32:33], v72 offset:24576
    ds_read_b64_tr_b16 v[34:35], v72 offset:25344
    v_mfma_f32_32x32x16_bf16 v[196:211], v[244:247], v[60:63], v[196:211]
    ds_read_b64_tr_b16 v[48:49], v72 offset:24640
    buffer_store_dwordx4 v[232:235], v85, s[64:67], 0 offen offset:1024 sc1
    s_waitcnt vmcnt(5)
    v_mfma_f32_32x32x16_bf16 v[180:195], v[110:113], a[112:115], v[180:195]
    ds_read_b64_tr_b16 v[50:51], v72 offset:25408
    ds_read_b128 a[216:219], v20 offset:16384
    v_mfma_f32_32x32x16_bf16 v[196:211], v[248:251], v[110:113], v[196:211]
    ds_read_b64_tr_b16 v[52:53], v72 offset:24704
    ds_read_b64_tr_b16 v[54:55], v72 offset:25472
    buffer_store_dwordx4 v[236:239], v85, s[64:67], s16 offen offset:0 sc1
    ds_read_b128 a[220:223], v20 offset:18432
    v_mfma_f32_32x32x16_bf16 v[132:147], v[114:117], a[112:115], v[132:147]
    ds_read_b128 a[248:251], v21 offset:16384
    ds_read_b128 a[252:255], v21 offset:18432
    v_mfma_f32_32x32x16_bf16 v[196:211], v[252:255], v[114:117], v[196:211]
    buffer_store_dwordx4 v[240:243], v85, s[64:67], s16 offen offset:1024 sc1
    buffer_load_dwordx4 v79, s[60:63], s81 offen offset:3072 lds
    ds_read_b64_tr_b16 v[60:61], v73 offset:24576
    ds_read_b64_tr_b16 v[62:63], v73 offset:25344
    ds_read_b64_tr_b16 v[110:111], v73 offset:24640
    ds_read_b64_tr_b16 v[112:113], v73 offset:25408
    ds_read_b64_tr_b16 v[114:115], v73 offset:24704
    ds_read_b64_tr_b16 v[116:117], v73 offset:25472
    v_add_u32 v3, 161792, v82
    s_waitcnt lgkmcnt(15)
    v_mfma_f32_32x32x16_bf16 v[148:163], v[118:121], a[116:119], v[148:163]
    v_mfma_f32_32x32x16_bf16 v[180:195], v[122:125], a[116:119], v[180:195]
    s_mov_b32 exec_hi, 0
    ds_write_b32 v3, v196 offset:0
    ds_write_b32 v3, v197 offset:512
    ds_write_b32 v3, v198 offset:1024
    s_mov_b64 exec, -1
    v_mfma_f32_32x32x16_bf16 v[132:147], v[126:129], a[116:119], v[132:147]
    s_waitcnt lgkmcnt(0)
    s_barrier
    ds_read_b128 v[164:167], v90 offset:14336
    ds_read_b128 v[168:171], v90 offset:14848
    ds_read_b128 v[172:175], v90 offset:15360
    v_mfma_f32_32x32x16_bf16 v[148:163], v[32:35], a[120:123], v[148:163]
    v_mfma_f32_32x32x16_bf16 v[148:163], v[60:63], a[124:127], v[148:163]
    s_waitcnt lgkmcnt(2)
    v_add_f32 v164, v164, v165
    v_add_f32 v166, v166, v167
    v_add_f32 v164, v164, v166
    v_cvt_pk_bf16_f32 v165, v164, v164
    v_mfma_f32_32x32x16_bf16 v[180:195], v[48:51], a[120:123], v[180:195]
    v_lshlrev_b32 v166, 16, v165
    v_sub_f32 v164, v164, v166
    v_cvt_pk_bf16_f32 v98, v166, v164
    v_mov_b32 v99, v56
    s_nop 1
    v_mfma_f32_32x32x16_bf16 v[148:163], v[98:101], v[94:97], v[148:163]
    s_waitcnt lgkmcnt(1)
    v_add_f32 v168, v168, v169
    v_add_f32 v170, v170, v171
    v_add_f32 v168, v168, v170
    v_cvt_pk_bf16_f32 v169, v168, v168
    v_mfma_f32_32x32x16_bf16 v[180:195], v[110:113], a[124:127], v[180:195]
    v_lshlrev_b32 v170, 16, v169
    v_sub_f32 v168, v168, v170
    v_cvt_pk_bf16_f32 v98, v170, v168
    v_mov_b32 v99, v57
    s_nop 1
    v_mfma_f32_32x32x16_bf16 v[180:195], v[98:101], v[94:97], v[180:195]
    s_waitcnt lgkmcnt(0)
    v_add_f32 v172, v172, v173
    v_add_f32 v174, v174, v175
    v_add_f32 v172, v172, v174
    v_cvt_pk_bf16_f32 v173, v172, v172
    v_mfma_f32_32x32x16_bf16 v[132:147], v[52:55], a[120:123], v[132:147]
    v_lshlrev_b32 v174, 16, v173
    v_sub_f32 v172, v172, v174
    v_cvt_pk_bf16_f32 v98, v174, v172
    v_mov_b32 v99, v58
    v_mfma_f32_32x32x16_bf16 v[132:147], v[114:117], a[124:127], v[132:147]
    v_max_f32 v148, 0, v148
    v_max_f32 v149, 0, v149
    v_mul_f32 v148, v148, v46
    v_mul_f32 v149, v149, v46
    v_mul_f32 v148, v148, v148
    v_mul_f32 v149, v149, v149
    v_cvt_pk_bf16_f32 v212, v148, v149
    s_nop 1
    v_mfma_f32_32x32x16_bf16 v[132:147], v[98:101], v[94:97], v[132:147]
    v_max_f32 v150, 0, v150
    v_max_f32 v151, 0, v151
    v_mul_f32 v150, v150, v46
    v_mul_f32 v151, v151, v46
    v_mul_f32 v150, v150, v150
    v_mul_f32 v151, v151, v151
    v_cvt_pk_bf16_f32 v213, v150, v151
    v_max_f32 v152, 0, v152
    v_max_f32 v153, 0, v153
    v_pk_mul_f32 v[152:153], v[152:153], v[46:47] op_sel_hi:[1,0]
    v_pk_mul_f32 v[152:153], v[152:153], v[152:153]
    v_cvt_pk_bf16_f32 v214, v152, v153
    v_max_f32 v154, 0, v154
    v_max_f32 v155, 0, v155
    v_pk_mul_f32 v[154:155], v[154:155], v[46:47] op_sel_hi:[1,0]
    v_pk_mul_f32 v[154:155], v[154:155], v[154:155]
    v_cvt_pk_bf16_f32 v215, v154, v155
    buffer_store_dwordx4 v[212:215], v88, s[64:67], 0 offen offset:0 sc1
    v_max_f32 v156, 0, v156
    v_max_f32 v157, 0, v157
    v_pk_mul_f32 v[156:157], v[156:157], v[46:47] op_sel_hi:[1,0]
    v_pk_mul_f32 v[156:157], v[156:157], v[156:157]
    v_cvt_pk_bf16_f32 v216, v156, v157
    v_max_f32 v158, 0, v158
    v_max_f32 v159, 0, v159
    v_pk_mul_f32 v[158:159], v[158:159], v[46:47] op_sel_hi:[1,0]
    v_pk_mul_f32 v[158:159], v[158:159], v[158:159]
    v_cvt_pk_bf16_f32 v217, v158, v159
    v_max_f32 v160, 0, v160
    v_max_f32 v161, 0, v161
    v_pk_mul_f32 v[160:161], v[160:161], v[46:47] op_sel_hi:[1,0]
    v_pk_mul_f32 v[160:161], v[160:161], v[160:161]
    v_cvt_pk_bf16_f32 v218, v160, v161
    v_max_f32 v162, 0, v162
    v_max_f32 v163, 0, v163
    v_pk_mul_f32 v[162:163], v[162:163], v[46:47] op_sel_hi:[1,0]
    v_pk_mul_f32 v[162:163], v[162:163], v[162:163]
    v_cvt_pk_bf16_f32 v219, v162, v163
    buffer_store_dwordx4 v[216:219], v88, s[64:67], 0 offen offset:512 sc1
    v_max_f32 v180, 0, v180
    v_max_f32 v181, 0, v181
    v_pk_mul_f32 v[180:181], v[180:181], v[46:47] op_sel_hi:[1,0]
    v_pk_mul_f32 v[180:181], v[180:181], v[180:181]
    v_cvt_pk_bf16_f32 v220, v180, v181
    v_max_f32 v182, 0, v182
    v_max_f32 v183, 0, v183
    v_pk_mul_f32 v[182:183], v[182:183], v[46:47] op_sel_hi:[1,0]
    v_pk_mul_f32 v[182:183], v[182:183], v[182:183]
    v_cvt_pk_bf16_f32 v221, v182, v183
    v_max_f32 v184, 0, v184
    v_max_f32 v185, 0, v185
    v_pk_mul_f32 v[184:185], v[184:185], v[46:47] op_sel_hi:[1,0]
    v_pk_mul_f32 v[184:185], v[184:185], v[184:185]
    v_cvt_pk_bf16_f32 v222, v184, v185
    v_max_f32 v186, 0, v186
    v_max_f32 v187, 0, v187
    v_pk_mul_f32 v[186:187], v[186:187], v[46:47] op_sel_hi:[1,0]
    v_pk_mul_f32 v[186:187], v[186:187], v[186:187]
    v_cvt_pk_bf16_f32 v223, v186, v187
    buffer_store_dwordx4 v[220:223], v88, s[64:67], s16 offen offset:0 sc1
    v_max_f32 v188, 0, v188
    v_max_f32 v189, 0, v189
    v_pk_mul_f32 v[188:189], v[188:189], v[46:47] op_sel_hi:[1,0]
    v_pk_mul_f32 v[188:189], v[188:189], v[188:189]
    v_cvt_pk_bf16_f32 v224, v188, v189
    v_max_f32 v190, 0, v190
    v_max_f32 v191, 0, v191
    v_pk_mul_f32 v[190:191], v[190:191], v[46:47] op_sel_hi:[1,0]
    v_pk_mul_f32 v[190:191], v[190:191], v[190:191]
    v_cvt_pk_bf16_f32 v225, v190, v191
    v_max_f32 v192, 0, v192
    v_max_f32 v193, 0, v193
    v_pk_mul_f32 v[192:193], v[192:193], v[46:47] op_sel_hi:[1,0]
    v_pk_mul_f32 v[192:193], v[192:193], v[192:193]
    v_cvt_pk_bf16_f32 v226, v192, v193
    v_max_f32 v194, 0, v194
    v_max_f32 v195, 0, v195
    v_pk_mul_f32 v[194:195], v[194:195], v[46:47] op_sel_hi:[1,0]
    v_pk_mul_f32 v[194:195], v[194:195], v[194:195]
    v_cvt_pk_bf16_f32 v227, v194, v195
    buffer_store_dwordx4 v[224:227], v88, s[64:67], s16 offen offset:512 sc1
    v_max_f32 v132, 0, v132
    v_max_f32 v133, 0, v133
    v_pk_mul_f32 v[132:133], v[132:133], v[46:47] op_sel_hi:[1,0]
    v_pk_mul_f32 v[132:133], v[132:133], v[132:133]
    v_cvt_pk_bf16_f32 v212, v132, v133
    v_max_f32 v134, 0, v134
    v_max_f32 v135, 0, v135
    v_pk_mul_f32 v[134:135], v[134:135], v[46:47] op_sel_hi:[1,0]
    v_pk_mul_f32 v[134:135], v[134:135], v[134:135]
    v_cvt_pk_bf16_f32 v213, v134, v135
    v_max_f32 v136, 0, v136
    v_max_f32 v137, 0, v137
    v_pk_mul_f32 v[136:137], v[136:137], v[46:47] op_sel_hi:[1,0]
    v_pk_mul_f32 v[136:137], v[136:137], v[136:137]
    v_cvt_pk_bf16_f32 v214, v136, v137
    v_max_f32 v138, 0, v138
    v_max_f32 v139, 0, v139
    v_pk_mul_f32 v[138:139], v[138:139], v[46:47] op_sel_hi:[1,0]
    v_pk_mul_f32 v[138:139], v[138:139], v[138:139]
    v_cvt_pk_bf16_f32 v215, v138, v139
    buffer_store_dwordx4 v[212:215], v88, s[64:67], s17 offen offset:0 sc1
    v_max_f32 v140, 0, v140
    v_max_f32 v141, 0, v141
    v_pk_mul_f32 v[140:141], v[140:141], v[46:47] op_sel_hi:[1,0]
    v_pk_mul_f32 v[140:141], v[140:141], v[140:141]
    v_cvt_pk_bf16_f32 v216, v140, v141
    v_max_f32 v142, 0, v142
    v_max_f32 v143, 0, v143
    v_pk_mul_f32 v[142:143], v[142:143], v[46:47] op_sel_hi:[1,0]
    v_pk_mul_f32 v[142:143], v[142:143], v[142:143]
    v_cvt_pk_bf16_f32 v217, v142, v143
    v_max_f32 v144, 0, v144
    v_max_f32 v145, 0, v145
    v_pk_mul_f32 v[144:145], v[144:145], v[46:47] op_sel_hi:[1,0]
    v_pk_mul_f32 v[144:145], v[144:145], v[144:145]
    v_cvt_pk_bf16_f32 v218, v144, v145
    v_max_f32 v146, 0, v146
    v_max_f32 v147, 0, v147
    v_pk_mul_f32 v[146:147], v[146:147], v[46:47] op_sel_hi:[1,0]
    v_pk_mul_f32 v[146:147], v[146:147], v[146:147]
    v_cvt_pk_bf16_f32 v219, v146, v147
    buffer_store_dwordx4 v[216:219], v88, s[64:67], s17 offen offset:512 sc1
    s_lshl_b32 s82, s75, 6
    s_lshr_b32 s83, s3, 1
    s_lshl_b32 s83, s83, 2
    s_add_u32 s82, s82, s83
    s_and_b32 s83, s3, 1
    s_lshl_b32 s83, s83, 4
    s_add_u32 s82, s82, s83
    v_add_u32 v1, s82, v10
    v_and_b32 v2, 15, v0
    s_lshl_b32 s83, s74, 7
    v_lshl_add_u32 v2, v2, 3, s83
    v_lshl_add_u32 v9, v1, 10, v2
    v_lshrrev_b32 v11, 1, v1
    v_lshlrev_b32 v11, 7, v11
    v_and_b32 v2, 1, v1
    v_lshl_add_u32 v11, v2, 3, v11
    v_add_u32 v11, 262144, v11
    v_and_b32 v1, 127, v1
    v_lshlrev_b32 v1, 2, v1
    v_add_u32 v1, 160256, v1
    ds_read_b32 v28, v1 offset:0
    ds_read_b32 v29, v1 offset:32
    ds_read_b32 v30, v1 offset:128
    ds_read_b32 v31, v1 offset:160
    v_lshrrev_b32 v3, 10, v9
    v_and_b32 v3, 63, v3
    v_and_b32 v2, 15, v0
    v_lshlrev_b32 v2, 3, v2
    v_lshl_add_u32 v3, v3, 7, v2
    ds_read_b64 v[12:13], v3 offset:36864
    ds_read_b64 v[14:15], v3 offset:37888
    ds_read_b64 v[20:21], v3 offset:40960
    ds_read_b64 v[22:23], v3 offset:41984
    s_waitcnt vmcnt(44)
    ds_read_b64_tr_b16 a[0:1], v16 offset:0
    ds_read_b64_tr_b16 a[2:3], v16 offset:1024
    ds_read_b64_tr_b16 a[4:5], v17 offset:0
    ds_read_b64_tr_b16 a[6:7], v17 offset:1024
    ds_read_b64_tr_b16 a[8:9], v18 offset:0
    ds_read_b64_tr_b16 a[10:11], v18 offset:1024
    ds_read_b64_tr_b16 a[12:13], v19 offset:0
    ds_read_b64_tr_b16 a[14:15], v19 offset:1024
    s_waitcnt vmcnt(30)
    ds_read_b64_tr_b16 a[16:17], v16 offset:16384
    ds_read_b64_tr_b16 a[18:19], v16 offset:17408
    ds_read_b64_tr_b16 a[20:21], v17 offset:16384
    ds_read_b64_tr_b16 a[22:23], v17 offset:17408
    ds_read_b64_tr_b16 a[24:25], v18 offset:16384
    ds_read_b64_tr_b16 a[26:27], v18 offset:17408
    ds_read_b64_tr_b16 a[28:29], v19 offset:16384
    ds_read_b64_tr_b16 a[30:31], v19 offset:17408
    s_waitcnt vmcnt(18)
    ds_read_b64_tr_b16 a[32:33], v16 offset:32768
    ds_read_b64_tr_b16 a[34:35], v16 offset:33792
    ds_read_b64_tr_b16 a[36:37], v17 offset:32768
    ds_read_b64_tr_b16 a[38:39], v17 offset:33792
    ds_read_b64_tr_b16 a[40:41], v18 offset:32768
    ds_read_b64_tr_b16 a[42:43], v18 offset:33792
    ds_read_b64_tr_b16 a[44:45], v19 offset:32768
    ds_read_b64_tr_b16 a[46:47], v19 offset:33792
    s_add_u32 m0, s78, 49152
    s_mov_b32 s81, 131072
    buffer_load_dwordx4 v76, s[60:63], s81 offen offset:0 lds
    buffer_load_dwordx4 v77, s[60:63], s81 offen offset:1024 lds
    buffer_load_dwordx4 v78, s[60:63], s81 offen offset:2048 lds
    buffer_load_dwordx4 v79, s[60:63], s81 offen offset:3072 lds
    s_lshl_b32 s82, s75, 17
    s_lshl_b32 s83, s3, 15
    s_add_u32 s82, s82, s83
    s_add_u32 s82, s82, 8388608
    v_lshl_add_u32 v40, v0, 4, s82
    s_mul_i32 s82, s75, 43
    s_mul_i32 s83, s3, 11
    s_add_u32 s82, s82, s83
    s_lshl_b32 s82, s82, 12
    s_add_u32 s82, s82, 1048576
    v_lshl_add_u32 v41, v0, 4, s82
    s_cmp_lt_u32 s3, 3
    s_cselect_b32 s84, 40960, 1073741824
    s_lshr_b32 s82, s75, 1
    s_lshl_b32 s82, s82, 11
    s_lshl_b32 s83, s3, 9
    s_max_u32 s83, s83, 128
    s_sub_u32 s83, s83, 128
    s_add_u32 s83, s83, s82
    s_add_u32 s83, s83, 196608
    s_add_u32 s88, s36, s83
    s_addc_u32 s89, s37, 0
    s_mov_b32 s85, 0x20000
    v_lshlrev_b32 v112, 16, v24
    v_and_b32 v113, 0xffff0000, v24
    v_lshlrev_b32 v116, 16, v26
    v_and_b32 v117, 0xffff0000, v26
    v_lshlrev_b32 v114, 16, v25
    v_and_b32 v115, 0xffff0000, v25
    v_lshlrev_b32 v118, 16, v27
    v_and_b32 v119, 0xffff0000, v27
    s_waitcnt vmcnt(4) lgkmcnt(0)
    s_barrier
    s_mov_b64 exec, 1
    buffer_store_dword v87, v86, s[64:67], 0 offen sc1
    s_mov_b64 exec, -1
    s_waitcnt lgkmcnt(0)
    v_and_b32 v121, 0xffff0000, v28
    v_rcp_f32 v121, v121
    v_lshlrev_b32 v120, 16, v28
    v_lshlrev_b32 v60, 16, v12
    v_and_b32 v61, 0xffff0000, v12
    s_add_u32 m0, s78, 65536
    s_mov_b32 s81, 163840
    buffer_load_dwordx4 v76, s[60:63], s81 offen offset:0 lds
    v_pk_add_f32 v[122:123], v[60:61], v[120:121] op_sel_hi:[1,0] neg_lo:[0,1] neg_hi:[0,1]
    v_cvt_pk_bf16_f32 v124, v122, v123
    v_lshlrev_b32 v122, 16, v124
    v_and_b32 v123, 0xffff0000, v124
    v_pk_mul_f32 v[122:123], v[122:123], v[120:121] op_sel:[0,1] op_sel_hi:[1,1]
    v_cvt_pk_bf16_f32 v124, v122, v123
    v_lshlrev_b32 v122, 16, v124
    buffer_load_dwordx4 v77, s[60:63], s81 offen offset:1024 lds
    v_and_b32 v123, 0xffff0000, v124
    v_pk_mul_f32 v[122:123], v[122:123], v[112:113]
    v_cvt_pk_bf16_f32 v124, v122, v123
    v_lshlrev_b32 v122, 16, v124
    v_and_b32 v123, 0xffff0000, v124
    v_pk_add_f32 v[60:61], v[60:61], v[122:123]
    buffer_load_dwordx4 v78, s[60:63], s81 offen offset:2048 lds
    v_pk_add_f32 v[60:61], v[60:61], v[116:117]
    v_lshlrev_b32 v62, 16, v13
    v_and_b32 v63, 0xffff0000, v13
    v_pk_add_f32 v[122:123], v[62:63], v[120:121] op_sel_hi:[1,0] neg_lo:[0,1] neg_hi:[0,1]
    v_cvt_pk_bf16_f32 v124, v122, v123
    v_lshlrev_b32 v122, 16, v124
    v_and_b32 v123, 0xffff0000, v124
    buffer_load_dwordx4 v79, s[60:63], s81 offen offset:3072 lds
    v_pk_mul_f32 v[122:123], v[122:123], v[120:121] op_sel:[0,1] op_sel_hi:[1,1]
    v_cvt_pk_bf16_f32 v124, v122, v123
    v_lshlrev_b32 v122, 16, v124
    v_and_b32 v123, 0xffff0000, v124
    v_pk_mul_f32 v[122:123], v[122:123], v[114:115]
    v_cvt_pk_bf16_f32 v124, v122, v123
    s_add_u32 m0, s78, 0
    s_mov_b32 s81, 196608
    buffer_load_dwordx4 v76, s[60:63], s81 offen offset:0 lds
    v_lshlrev_b32 v122, 16, v124
    v_and_b32 v123, 0xffff0000, v124
    v_pk_add_f32 v[62:63], v[62:63], v[122:123]
    v_pk_add_f32 v[62:63], v[62:63], v[118:119]
    v_and_b32 v121, 0xffff0000, v29
    v_rcp_f32 v121, v121
    buffer_load_dwordx4 v77, s[60:63], s81 offen offset:1024 lds
    v_lshlrev_b32 v120, 16, v29
    v_lshlrev_b32 v64, 16, v14
    v_and_b32 v65, 0xffff0000, v14
    v_pk_add_f32 v[122:123], v[64:65], v[120:121] op_sel_hi:[1,0] neg_lo:[0,1] neg_hi:[0,1]
    v_cvt_pk_bf16_f32 v124, v122, v123
    v_lshlrev_b32 v122, 16, v124
    v_and_b32 v123, 0xffff0000, v124
    buffer_load_dwordx4 v78, s[60:63], s81 offen offset:2048 lds
    v_pk_mul_f32 v[122:123], v[122:123], v[120:121] op_sel:[0,1] op_sel_hi:[1,1]
    v_cvt_pk_bf16_f32 v124, v122, v123
    v_lshlrev_b32 v122, 16, v124
    v_and_b32 v123, 0xffff0000, v124
    v_pk_mul_f32 v[122:123], v[122:123], v[112:113]
    v_cvt_pk_bf16_f32 v124, v122, v123
    buffer_load_dwordx4 v79, s[60:63], s81 offen offset:3072 lds
    v_lshlrev_b32 v122, 16, v124
    v_and_b32 v123, 0xffff0000, v124
    v_pk_add_f32 v[64:65], v[64:65], v[122:123]
    v_pk_add_f32 v[64:65], v[64:65], v[116:117]
    v_lshlrev_b32 v66, 16, v15
    v_and_b32 v67, 0xffff0000, v15
    v_pk_add_f32 v[122:123], v[66:67], v[120:121] op_sel_hi:[1,0] neg_lo:[0,1] neg_hi:[0,1]
    s_add_u32 m0, s78, 16384
    s_mov_b32 s81, 229376
    buffer_load_dwordx4 v76, s[60:63], s81 offen offset:0 lds
    v_cvt_pk_bf16_f32 v124, v122, v123
    v_lshlrev_b32 v122, 16, v124
    v_and_b32 v123, 0xffff0000, v124
    v_pk_mul_f32 v[122:123], v[122:123], v[120:121] op_sel:[0,1] op_sel_hi:[1,1]
    v_cvt_pk_bf16_f32 v124, v122, v123
    v_lshlrev_b32 v122, 16, v124
    buffer_load_dwordx4 v77, s[60:63], s81 offen offset:1024 lds
    v_and_b32 v123, 0xffff0000, v124
    v_pk_mul_f32 v[122:123], v[122:123], v[114:115]
    v_cvt_pk_bf16_f32 v124, v122, v123
    v_lshlrev_b32 v122, 16, v124
    v_and_b32 v123, 0xffff0000, v124
    v_pk_add_f32 v[66:67], v[66:67], v[122:123]
    v_pk_add_f32 v[66:67], v[66:67], v[118:119]
    buffer_load_dwordx4 v78, s[60:63], s81 offen offset:2048 lds
    v_and_b32 v121, 0xffff0000, v30
    v_rcp_f32 v121, v121
    v_lshlrev_b32 v120, 16, v30
    v_lshlrev_b32 v68, 16, v20
    v_and_b32 v69, 0xffff0000, v20
    v_pk_add_f32 v[122:123], v[68:69], v[120:121] op_sel_hi:[1,0] neg_lo:[0,1] neg_hi:[0,1]
    buffer_load_dwordx4 v79, s[60:63], s81 offen offset:3072 lds
    v_cvt_pk_bf16_f32 v124, v122, v123
    v_lshlrev_b32 v122, 16, v124
    v_and_b32 v123, 0xffff0000, v124
    v_pk_mul_f32 v[122:123], v[122:123], v[120:121] op_sel:[0,1] op_sel_hi:[1,1]
    v_cvt_pk_bf16_f32 v124, v122, v123
    v_lshlrev_b32 v122, 16, v124
    s_add_u32 m0, s78, 32768
    s_mov_b32 s81, 262144
    buffer_load_dwordx4 v76, s[60:63], s81 offen offset:0 lds
    v_and_b32 v123, 0xffff0000, v124
    v_pk_mul_f32 v[122:123], v[122:123], v[112:113]
    v_cvt_pk_bf16_f32 v124, v122, v123
    v_lshlrev_b32 v122, 16, v124
    v_and_b32 v123, 0xffff0000, v124
    v_pk_add_f32 v[68:69], v[68:69], v[122:123]
    v_pk_add_f32 v[68:69], v[68:69], v[116:117]
    buffer_load_dwordx4 v77, s[60:63], s81 offen offset:1024 lds
    v_lshlrev_b32 v70, 16, v21
    v_and_b32 v71, 0xffff0000, v21
    v_pk_add_f32 v[122:123], v[70:71], v[120:121] op_sel_hi:[1,0] neg_lo:[0,1] neg_hi:[0,1]
    v_cvt_pk_bf16_f32 v124, v122, v123
    v_lshlrev_b32 v122, 16, v124
    v_and_b32 v123, 0xffff0000, v124
    buffer_load_dwordx4 v78, s[60:63], s81 offen offset:2048 lds
    v_pk_mul_f32 v[122:123], v[122:123], v[120:121] op_sel:[0,1] op_sel_hi:[1,1]
    v_cvt_pk_bf16_f32 v124, v122, v123
    v_lshlrev_b32 v122, 16, v124
    v_and_b32 v123, 0xffff0000, v124
    v_pk_mul_f32 v[122:123], v[122:123], v[114:115]
    v_cvt_pk_bf16_f32 v124, v122, v123
    v_lshlrev_b32 v122, 16, v124
    buffer_load_dwordx4 v79, s[60:63], s81 offen offset:3072 lds
    v_and_b32 v123, 0xffff0000, v124
    v_pk_add_f32 v[70:71], v[70:71], v[122:123]
    v_pk_add_f32 v[70:71], v[70:71], v[118:119]
    v_and_b32 v121, 0xffff0000, v31
    v_rcp_f32 v121, v121
    v_lshlrev_b32 v120, 16, v31
    s_add_u32 m0, s78, 98304
    s_mov_b32 s81, 294912
    buffer_load_dwordx4 v76, s[60:63], s81 offen offset:0 lds
    v_lshlrev_b32 v72, 16, v22
    v_and_b32 v73, 0xffff0000, v22
    v_pk_add_f32 v[122:123], v[72:73], v[120:121] op_sel_hi:[1,0] neg_lo:[0,1] neg_hi:[0,1]
    v_cvt_pk_bf16_f32 v124, v122, v123
    v_lshlrev_b32 v122, 16, v124
    v_and_b32 v123, 0xffff0000, v124
    buffer_load_dwordx4 v77, s[60:63], s81 offen offset:1024 lds
    v_pk_mul_f32 v[122:123], v[122:123], v[120:121] op_sel:[0,1] op_sel_hi:[1,1]
    v_cvt_pk_bf16_f32 v124, v122, v123
    v_lshlrev_b32 v122, 16, v124
    v_and_b32 v123, 0xffff0000, v124
    v_pk_mul_f32 v[122:123], v[122:123], v[112:113]
    v_cvt_pk_bf16_f32 v124, v122, v123
    v_lshlrev_b32 v122, 16, v124
    buffer_load_dwordx4 v78, s[60:63], s81 offen offset:2048 lds
    s_load_dword s4, s[88:89], 0 glc
    s_load_dword s5, s[88:89], 128 glc
    s_load_dword s6, s[88:89], 256 glc
    s_load_dword s7, s[88:89], 384 glc
    s_load_dword s8, s[88:89], 512 glc
    v_and_b32 v123, 0xffff0000, v124
    v_pk_add_f32 v[72:73], v[72:73], v[122:123]
    v_pk_add_f32 v[72:73], v[72:73], v[116:117]
    v_lshlrev_b32 v74, 16, v23
    v_and_b32 v75, 0xffff0000, v23
    v_pk_add_f32 v[122:123], v[74:75], v[120:121] op_sel_hi:[1,0] neg_lo:[0,1] neg_hi:[0,1]
    buffer_load_dwordx4 v79, s[60:63], s81 offen offset:3072 lds
    v_cvt_pk_bf16_f32 v124, v122, v123
    v_lshlrev_b32 v122, 16, v124
    v_and_b32 v123, 0xffff0000, v124
    v_pk_mul_f32 v[122:123], v[122:123], v[120:121] op_sel:[0,1] op_sel_hi:[1,1]
    v_cvt_pk_bf16_f32 v124, v122, v123
    v_lshlrev_b32 v122, 16, v124
    v_and_b32 v123, 0xffff0000, v124
    s_add_u32 m0, s78, 114688
    s_mov_b32 s81, 327680
    buffer_load_dwordx4 v76, s[60:63], s81 offen offset:0 lds
    v_pk_mul_f32 v[122:123], v[122:123], v[114:115]
    v_cvt_pk_bf16_f32 v124, v122, v123
    v_lshlrev_b32 v122, 16, v124
    v_and_b32 v123, 0xffff0000, v124
    v_pk_add_f32 v[74:75], v[74:75], v[122:123]
    v_pk_add_f32 v[74:75], v[74:75], v[118:119]
    buffer_load_dwordx4 v77, s[60:63], s81 offen offset:1024 lds
    v_and_b32 v1, 15, v0
    v_lshlrev_b32 v2, 8, v1
    v_add_u32 v2, s78, v2
    v_add_u32 v3, 0, v10
    v_xor_b32 v3, v3, v1
    v_lshl_add_u32 v42, v3, 4, v2
    buffer_load_dwordx4 v78, s[60:63], s81 offen offset:2048 lds
    v_add_u32 v3, 4, v10
    v_xor_b32 v3, v3, v1
    v_lshl_add_u32 v43, v3, 4, v2
    v_add_u32 v3, 8, v10
    v_xor_b32 v3, v3, v1
    v_lshl_add_u32 v44, v3, 4, v2
    v_add_u32 v3, 12, v10
    buffer_load_dwordx4 v79, s[60:63], s81 offen offset:3072 lds
    v_xor_b32 v3, v3, v1
    v_lshl_add_u32 v45, v3, 4, v2
    s_lshl_b32 s82, s3, 2
    v_add_u32 v3, s82, v10
    v_xor_b32 v4, v3, v1
    v_lshlrev_b32 v4, 4, v4
    v_lshl_add_u32 v46, v3, 8, v4
    v_lshlrev_b32 v9, 1, v9
L_chk_m:
    s_waitcnt lgkmcnt(0)
    s_cmp_eq_u32 s4, s72
    s_cbranch_scc0 L_slow_m
    s_cmp_eq_u32 s5, s72
    s_cbranch_scc0 L_slow_m
    s_cmp_eq_u32 s6, s72
    s_cbranch_scc0 L_slow_m
    s_cmp_eq_u32 s7, s72
    s_cbranch_scc0 L_slow_m
    s_cmp_eq_u32 s8, s72
    s_cbranch_scc0 L_slow_m
L_back_m:
    s_mov_b32 s81, 0
    buffer_load_dwordx4 v[176:179], v41, s[64:67], s81 offen offset:0 sc1
    buffer_load_dwordx4 v[180:183], v41, s[64:67], s81 offen offset:1024 sc1
    buffer_load_dwordx4 v[184:187], v41, s[64:67], s81 offen offset:2048 sc1
    buffer_load_dwordx4 v[188:191], v41, s[64:67], s81 offen offset:3072 sc1
    s_mov_b32 s81, 4096
    buffer_load_dwordx4 v[160:163], v41, s[64:67], s81 offen offset:0 sc1
    buffer_load_dwordx4 v[164:167], v41, s[64:67], s81 offen offset:1024 sc1
    buffer_load_dwordx4 v[168:171], v41, s[64:67], s81 offen offset:2048 sc1
    buffer_load_dwordx4 v[172:175], v41, s[64:67], s81 offen offset:3072 sc1
    s_mov_b32 s81, 8192
    buffer_load_dwordx4 v[144:147], v41, s[64:67], s81 offen offset:0 sc1
    buffer_load_dwordx4 v[148:151], v41, s[64:67], s81 offen offset:1024 sc1
    buffer_load_dwordx4 v[152:155], v41, s[64:67], s81 offen offset:2048 sc1
    buffer_load_dwordx4 v[156:159], v41, s[64:67], s81 offen offset:3072 sc1
    s_mov_b32 s81, 12288
    buffer_load_dwordx4 v[128:131], v41, s[64:67], s81 offen offset:0 sc1
    buffer_load_dwordx4 v[132:135], v41, s[64:67], s81 offen offset:1024 sc1
    buffer_load_dwordx4 v[136:139], v41, s[64:67], s81 offen offset:2048 sc1
    buffer_load_dwordx4 v[140:143], v41, s[64:67], s81 offen offset:3072 sc1
    s_mov_b32 s12, 16384
    s_mov_b32 s13, 20480
    s_mov_b32 s14, 24576
    s_mov_b32 s15, 28672
    s_waitcnt vmcnt(12)
    v_mfma_f32_16x16x32_bf16 v[192:195], a[0:3], v[176:179], 0
    v_mfma_f32_16x16x32_bf16 v[196:199], a[4:7], v[176:179], 0
    v_mfma_f32_16x16x32_bf16 v[200:203], a[8:11], v[176:179], 0
    v_mfma_f32_16x16x32_bf16 v[204:207], a[12:15], v[176:179], 0
    s_mov_b32 s81, 16384
    buffer_load_dwordx4 v[112:115], v41, s[64:67], s81 offen offset:0 sc1
    v_mfma_f32_16x16x32_bf16 v[220:223], a[12:15], v[180:183], 0
    v_mfma_f32_16x16x32_bf16 v[216:219], a[8:11], v[180:183], 0
    v_mfma_f32_16x16x32_bf16 v[212:215], a[4:7], v[180:183], 0
    buffer_load_dwordx4 v[116:119], v41, s[64:67], s81 offen offset:1024 sc1
    v_mfma_f32_16x16x32_bf16 v[208:211], a[0:3], v[180:183], 0
    v_mfma_f32_16x16x32_bf16 v[224:227], a[0:3], v[184:187], 0
    v_mfma_f32_16x16x32_bf16 v[228:231], a[4:7], v[184:187], 0
    v_mfma_f32_16x16x32_bf16 v[232:235], a[8:11], v[184:187], 0
    buffer_load_dwordx4 v[120:123], v41, s[64:67], s81 offen offset:2048 sc1
    v_mfma_f32_16x16x32_bf16 v[236:239], a[12:15], v[184:187], 0
    v_mfma_f32_16x16x32_bf16 v[252:255], a[12:15], v[188:191], 0
    v_mfma_f32_16x16x32_bf16 v[248:251], a[8:11], v[188:191], 0
    buffer_load_dwordx4 v[124:127], v41, s[64:67], s81 offen offset:3072 sc1
    v_mfma_f32_16x16x32_bf16 v[244:247], a[4:7], v[188:191], 0
    v_mfma_f32_16x16x32_bf16 v[240:243], a[0:3], v[188:191], 0
    s_waitcnt vmcnt(12)
    v_mfma_f32_16x16x32_bf16 v[192:195], a[16:19], v[160:163], v[192:195]
    v_mfma_f32_16x16x32_bf16 v[196:199], a[20:23], v[160:163], v[196:199]
    v_mfma_f32_16x16x32_bf16 v[200:203], a[24:27], v[160:163], v[200:203]
    s_waitcnt vmcnt(55)
    v_mfma_f32_16x16x32_bf16 v[204:207], a[28:31], v[160:163], v[204:207]
    s_mov_b32 s81, 20480
    buffer_load_dwordx4 v[96:99], v41, s[64:67], s81 offen offset:0 sc1
    v_subrev_u32 v16, 49152, v16
    v_mfma_f32_16x16x32_bf16 v[220:223], a[28:31], v[164:167], v[220:223]
    v_subrev_u32 v17, 49152, v17
    v_mfma_f32_16x16x32_bf16 v[216:219], a[24:27], v[164:167], v[216:219]
    v_subrev_u32 v18, 49152, v18
    v_mfma_f32_16x16x32_bf16 v[212:215], a[20:23], v[164:167], v[212:215]
    buffer_load_dwordx4 v[100:103], v41, s[64:67], s81 offen offset:1024 sc1
    v_subrev_u32 v19, 49152, v19
    v_mfma_f32_16x16x32_bf16 v[208:211], a[16:19], v[164:167], v[208:211]
    ds_read_b64_tr_b16 a[48:49], v16 offset:32768
    v_mfma_f32_16x16x32_bf16 v[224:227], a[16:19], v[168:171], v[224:227]
    ds_read_b64_tr_b16 a[50:51], v16 offset:33792
    v_mfma_f32_16x16x32_bf16 v[228:231], a[20:23], v[168:171], v[228:231]
    ds_read_b64_tr_b16 a[52:53], v17 offset:32768
    v_mfma_f32_16x16x32_bf16 v[232:235], a[24:27], v[168:171], v[232:235]
    buffer_load_dwordx4 v[104:107], v41, s[64:67], s81 offen offset:2048 sc1
    v_mfma_f32_16x16x32_bf16 v[236:239], a[28:31], v[168:171], v[236:239]
    ds_read_b64_tr_b16 a[54:55], v17 offset:33792
    v_mfma_f32_16x16x32_bf16 v[252:255], a[28:31], v[172:175], v[252:255]
    ds_read_b64_tr_b16 a[56:57], v18 offset:32768
    v_mfma_f32_16x16x32_bf16 v[248:251], a[24:27], v[172:175], v[248:251]
    buffer_load_dwordx4 v[108:111], v41, s[64:67], s81 offen offset:3072 sc1
    ds_read_b64_tr_b16 a[58:59], v18 offset:33792
    v_mfma_f32_16x16x32_bf16 v[244:247], a[20:23], v[172:175], v[244:247]
    ds_read_b64_tr_b16 a[60:61], v19 offset:32768
    v_mfma_f32_16x16x32_bf16 v[240:243], a[16:19], v[172:175], v[240:243]
    ds_read_b64_tr_b16 a[62:63], v19 offset:33792
    s_waitcnt vmcnt(12)
    v_mfma_f32_16x16x32_bf16 v[192:195], a[32:35], v[144:147], v[192:195]
    v_mfma_f32_16x16x32_bf16 v[196:199], a[36:39], v[144:147], v[196:199]
    v_mfma_f32_16x16x32_bf16 v[200:203], a[40:43], v[144:147], v[200:203]
    s_waitcnt vmcnt(49)
    v_mfma_f32_16x16x32_bf16 v[204:207], a[44:47], v[144:147], v[204:207]
    s_mov_b32 s81, 24576
    buffer_load_dwordx4 v[176:179], v41, s[64:67], s81 offen offset:0 sc1
    v_mfma_f32_16x16x32_bf16 v[220:223], a[44:47], v[148:151], v[220:223]
    ds_read_b64_tr_b16 a[64:65], v16 offset:0
    v_mfma_f32_16x16x32_bf16 v[216:219], a[40:43], v[148:151], v[216:219]
    ds_read_b64_tr_b16 a[66:67], v16 offset:1024
    v_mfma_f32_16x16x32_bf16 v[212:215], a[36:39], v[148:151], v[212:215]
    buffer_load_dwordx4 v[180:183], v41, s[64:67], s81 offen offset:1024 sc1
    v_mfma_f32_16x16x32_bf16 v[208:211], a[32:35], v[148:151], v[208:211]
    ds_read_b64_tr_b16 a[68:69], v17 offset:0
    v_mfma_f32_16x16x32_bf16 v[224:227], a[32:35], v[152:155], v[224:227]
    v_mfma_f32_16x16x32_bf16 v[228:231], a[36:39], v[152:155], v[228:231]
    ds_read_b64_tr_b16 a[70:71], v17 offset:1024
    v_mfma_f32_16x16x32_bf16 v[232:235], a[40:43], v[152:155], v[232:235]
    buffer_load_dwordx4 v[184:187], v41, s[64:67], s81 offen offset:2048 sc1
    ds_read_b64_tr_b16 a[72:73], v18 offset:0
    v_mfma_f32_16x16x32_bf16 v[236:239], a[44:47], v[152:155], v[236:239]
    v_mfma_f32_16x16x32_bf16 v[252:255], a[44:47], v[156:159], v[252:255]
    ds_read_b64_tr_b16 a[74:75], v18 offset:1024
    v_mfma_f32_16x16x32_bf16 v[248:251], a[40:43], v[156:159], v[248:251]
    buffer_load_dwordx4 v[188:191], v41, s[64:67], s81 offen offset:3072 sc1
    ds_read_b64_tr_b16 a[76:77], v19 offset:0
    v_mfma_f32_16x16x32_bf16 v[244:247], a[36:39], v[156:159], v[244:247]
    v_mfma_f32_16x16x32_bf16 v[240:243], a[32:35], v[156:159], v[240:243]
    ds_read_b64_tr_b16 a[78:79], v19 offset:1024
    s_waitcnt vmcnt(12) lgkmcnt(8)
    v_mfma_f32_16x16x32_bf16 v[192:195], a[48:51], v[128:131], v[192:195]
    v_mfma_f32_16x16x32_bf16 v[196:199], a[52:55], v[128:131], v[196:199]
    v_mfma_f32_16x16x32_bf16 v[200:203], a[56:59], v[128:131], v[200:203]
    s_waitcnt vmcnt(48)
    v_mfma_f32_16x16x32_bf16 v[204:207], a[60:63], v[128:131], v[204:207]
    s_mov_b32 s81, 28672
    buffer_load_dwordx4 v[160:163], v41, s[64:67], s81 offen offset:0 sc1
    v_mfma_f32_16x16x32_bf16 v[220:223], a[60:63], v[132:135], v[220:223]
    ds_read_b64_tr_b16 a[80:81], v16 offset:16384
    v_mfma_f32_16x16x32_bf16 v[216:219], a[56:59], v[132:135], v[216:219]
    ds_read_b64_tr_b16 a[82:83], v16 offset:17408
    v_mfma_f32_16x16x32_bf16 v[212:215], a[52:55], v[132:135], v[212:215]
    buffer_load_dwordx4 v[164:167], v41, s[64:67], s81 offen offset:1024 sc1
    v_mfma_f32_16x16x32_bf16 v[208:211], a[48:51], v[132:135], v[208:211]
    ds_read_b64_tr_b16 a[84:85], v17 offset:16384
    v_mfma_f32_16x16x32_bf16 v[224:227], a[48:51], v[136:139], v[224:227]
    v_mfma_f32_16x16x32_bf16 v[228:231], a[52:55], v[136:139], v[228:231]
    ds_read_b64_tr_b16 a[86:87], v17 offset:17408
    v_mfma_f32_16x16x32_bf16 v[232:235], a[56:59], v[136:139], v[232:235]
    buffer_load_dwordx4 v[168:171], v41, s[64:67], s81 offen offset:2048 sc1
    ds_read_b64_tr_b16 a[88:89], v18 offset:16384
    v_mfma_f32_16x16x32_bf16 v[236:239], a[60:63], v[136:139], v[236:239]
    v_mfma_f32_16x16x32_bf16 v[252:255], a[60:63], v[140:143], v[252:255]
    ds_read_b64_tr_b16 a[90:91], v18 offset:17408
    v_mfma_f32_16x16x32_bf16 v[248:251], a[56:59], v[140:143], v[248:251]
    buffer_load_dwordx4 v[172:175], v41, s[64:67], s81 offen offset:3072 sc1
    ds_read_b64_tr_b16 a[92:93], v19 offset:16384
    v_mfma_f32_16x16x32_bf16 v[244:247], a[52:55], v[140:143], v[244:247]
    v_mfma_f32_16x16x32_bf16 v[240:243], a[48:51], v[140:143], v[240:243]
    ds_read_b64_tr_b16 a[94:95], v19 offset:17408
    s_waitcnt vmcnt(12) lgkmcnt(8)
    v_mfma_f32_16x16x32_bf16 v[192:195], a[64:67], v[112:115], v[192:195]
    v_mfma_f32_16x16x32_bf16 v[196:199], a[68:71], v[112:115], v[196:199]
    v_mfma_f32_16x16x32_bf16 v[200:203], a[72:75], v[112:115], v[200:203]
    s_waitcnt vmcnt(48)
    v_mfma_f32_16x16x32_bf16 v[204:207], a[76:79], v[112:115], v[204:207]
    s_mov_b32 s81, 32768
    buffer_load_dwordx4 v[144:147], v41, s[64:67], s81 offen offset:0 sc1
    v_subrev_u32 v16, 49152, v16
    v_mfma_f32_16x16x32_bf16 v[220:223], a[76:79], v[116:119], v[220:223]
    v_subrev_u32 v17, 49152, v17
    v_mfma_f32_16x16x32_bf16 v[216:219], a[72:75], v[116:119], v[216:219]
    v_subrev_u32 v18, 49152, v18
    v_mfma_f32_16x16x32_bf16 v[212:215], a[68:71], v[116:119], v[212:215]
    buffer_load_dwordx4 v[148:151], v41, s[64:67], s81 offen offset:1024 sc1
    v_subrev_u32 v19, 49152, v19
    v_mfma_f32_16x16x32_bf16 v[208:211], a[64:67], v[116:119], v[208:211]
    ds_read_b64_tr_b16 a[96:97], v16 offset:0
    v_mfma_f32_16x16x32_bf16 v[224:227], a[64:67], v[120:123], v[224:227]
    ds_read_b64_tr_b16 a[98:99], v16 offset:1024
    v_mfma_f32_16x16x32_bf16 v[228:231], a[68:71], v[120:123], v[228:231]
    ds_read_b64_tr_b16 a[100:101], v17 offset:0
    v_mfma_f32_16x16x32_bf16 v[232:235], a[72:75], v[120:123], v[232:235]
    buffer_load_dwordx4 v[152:155], v41, s[64:67], s81 offen offset:2048 sc1
    v_mfma_f32_16x16x32_bf16 v[236:239], a[76:79], v[120:123], v[236:239]
    ds_read_b64_tr_b16 a[102:103], v17 offset:1024
    v_mfma_f32_16x16x32_bf16 v[252:255], a[76:79], v[124:127], v[252:255]
    ds_read_b64_tr_b16 a[104:105], v18 offset:0
    v_mfma_f32_16x16x32_bf16 v[248:251], a[72:75], v[124:127], v[248:251]
    buffer_load_dwordx4 v[156:159], v41, s[64:67], s81 offen offset:3072 sc1
    ds_read_b64_tr_b16 a[106:107], v18 offset:1024
    v_mfma_f32_16x16x32_bf16 v[244:247], a[68:71], v[124:127], v[244:247]
    ds_read_b64_tr_b16 a[108:109], v19 offset:0
    v_mfma_f32_16x16x32_bf16 v[240:243], a[64:67], v[124:127], v[240:243]
    ds_read_b64_tr_b16 a[110:111], v19 offset:1024
    s_waitcnt vmcnt(12) lgkmcnt(8)
    v_mfma_f32_16x16x32_bf16 v[192:195], a[80:83], v[96:99], v[192:195]
    v_mfma_f32_16x16x32_bf16 v[196:199], a[84:87], v[96:99], v[196:199]
    v_mfma_f32_16x16x32_bf16 v[200:203], a[88:91], v[96:99], v[200:203]
    s_waitcnt vmcnt(48)
    v_mfma_f32_16x16x32_bf16 v[204:207], a[92:95], v[96:99], v[204:207]
    s_mov_b32 s81, 36864
    buffer_load_dwordx4 v[128:131], v41, s[64:67], s81 offen offset:0 sc1
    v_mfma_f32_16x16x32_bf16 v[220:223], a[92:95], v[100:103], v[220:223]
    ds_read_b64_tr_b16 a[112:113], v16 offset:16384
    v_mfma_f32_16x16x32_bf16 v[216:219], a[88:91], v[100:103], v[216:219]
    ds_read_b64_tr_b16 a[114:115], v16 offset:17408
    v_mfma_f32_16x16x32_bf16 v[212:215], a[84:87], v[100:103], v[212:215]
    buffer_load_dwordx4 v[132:135], v41, s[64:67], s81 offen offset:1024 sc1
    v_mfma_f32_16x16x32_bf16 v[208:211], a[80:83], v[100:103], v[208:211]
    ds_read_b64_tr_b16 a[116:117], v17 offset:16384
    v_mfma_f32_16x16x32_bf16 v[224:227], a[80:83], v[104:107], v[224:227]
    v_mfma_f32_16x16x32_bf16 v[228:231], a[84:87], v[104:107], v[228:231]
    ds_read_b64_tr_b16 a[118:119], v17 offset:17408
    v_mfma_f32_16x16x32_bf16 v[232:235], a[88:91], v[104:107], v[232:235]
    buffer_load_dwordx4 v[136:139], v41, s[64:67], s81 offen offset:2048 sc1
    ds_read_b64_tr_b16 a[120:121], v18 offset:16384
    v_mfma_f32_16x16x32_bf16 v[236:239], a[92:95], v[104:107], v[236:239]
    v_mfma_f32_16x16x32_bf16 v[252:255], a[92:95], v[108:111], v[252:255]
    ds_read_b64_tr_b16 a[122:123], v18 offset:17408
    v_mfma_f32_16x16x32_bf16 v[248:251], a[88:91], v[108:111], v[248:251]
    buffer_load_dwordx4 v[140:143], v41, s[64:67], s81 offen offset:3072 sc1
    ds_read_b64_tr_b16 a[124:125], v19 offset:16384
    v_mfma_f32_16x16x32_bf16 v[244:247], a[84:87], v[108:111], v[244:247]
    v_mfma_f32_16x16x32_bf16 v[240:243], a[80:83], v[108:111], v[240:243]
    ds_read_b64_tr_b16 a[126:127], v19 offset:17408
    s_waitcnt vmcnt(12) lgkmcnt(8)
    v_mfma_f32_16x16x32_bf16 v[192:195], a[96:99], v[176:179], v[192:195]
    v_mfma_f32_16x16x32_bf16 v[196:199], a[100:103], v[176:179], v[196:199]
    v_mfma_f32_16x16x32_bf16 v[200:203], a[104:107], v[176:179], v[200:203]
    s_waitcnt vmcnt(48)
    v_mfma_f32_16x16x32_bf16 v[204:207], a[108:111], v[176:179], v[204:207]
    buffer_load_dwordx4 v[112:115], v41, s[64:67], s84 offen offset:0 sc1
    v_mfma_f32_16x16x32_bf16 v[220:223], a[108:111], v[180:183], v[220:223]
    ds_read_b64_tr_b16 a[0:1], v16 offset:32768
    v_mfma_f32_16x16x32_bf16 v[216:219], a[104:107], v[180:183], v[216:219]
    ds_read_b64_tr_b16 a[2:3], v16 offset:33792
    v_mfma_f32_16x16x32_bf16 v[212:215], a[100:103], v[180:183], v[212:215]
    buffer_load_dwordx4 v[116:119], v41, s[64:67], s84 offen offset:1024 sc1
    v_mfma_f32_16x16x32_bf16 v[208:211], a[96:99], v[180:183], v[208:211]
    ds_read_b64_tr_b16 a[4:5], v17 offset:32768
    v_mfma_f32_16x16x32_bf16 v[224:227], a[96:99], v[184:187], v[224:227]
    v_mfma_f32_16x16x32_bf16 v[228:231], a[100:103], v[184:187], v[228:231]
    ds_read_b64_tr_b16 a[6:7], v17 offset:33792
    v_mfma_f32_16x16x32_bf16 v[232:235], a[104:107], v[184:187], v[232:235]
    buffer_load_dwordx4 v[120:123], v41, s[64:67], s84 offen offset:2048 sc1
    ds_read_b64_tr_b16 a[8:9], v18 offset:32768
    v_mfma_f32_16x16x32_bf16 v[236:239], a[108:111], v[184:187], v[236:239]
    v_mfma_f32_16x16x32_bf16 v[252:255], a[108:111], v[188:191], v[252:255]
    ds_read_b64_tr_b16 a[10:11], v18 offset:33792
    v_mfma_f32_16x16x32_bf16 v[248:251], a[104:107], v[188:191], v[248:251]
    buffer_load_dwordx4 v[124:127], v41, s[64:67], s84 offen offset:3072 sc1
    ds_read_b64_tr_b16 a[12:13], v19 offset:32768
    v_mfma_f32_16x16x32_bf16 v[244:247], a[100:103], v[188:191], v[244:247]
    v_mfma_f32_16x16x32_bf16 v[240:243], a[96:99], v[188:191], v[240:243]
    ds_read_b64_tr_b16 a[14:15], v19 offset:33792
    s_waitcnt vmcnt(12) lgkmcnt(8)
    v_mfma_f32_16x16x32_bf16 v[192:195], a[112:115], v[160:163], v[192:195]
    v_mfma_f32_16x16x32_bf16 v[196:199], a[116:119], v[160:163], v[196:199]
    v_mfma_f32_16x16x32_bf16 v[200:203], a[120:123], v[160:163], v[200:203]
    s_waitcnt vmcnt(48)
    v_mfma_f32_16x16x32_bf16 v[204:207], a[124:127], v[160:163], v[204:207]
    s_mov_b32 s81, 0
    buffer_load_dwordx4 v[96:99], v40, s[64:67], s81 offen offset:0 sc1
    v_add_u32 v16, 98304, v16
    v_mfma_f32_16x16x32_bf16 v[220:223], a[124:127], v[164:167], v[220:223]
    v_add_u32 v17, 98304, v17
    v_mfma_f32_16x16x32_bf16 v[216:219], a[120:123], v[164:167], v[216:219]
    v_add_u32 v18, 98304, v18
    v_mfma_f32_16x16x32_bf16 v[212:215], a[116:119], v[164:167], v[212:215]
    buffer_load_dwordx4 v[100:103], v40, s[64:67], s81 offen offset:1024 sc1
    v_add_u32 v19, 98304, v19
    v_mfma_f32_16x16x32_bf16 v[208:211], a[112:115], v[164:167], v[208:211]
    ds_read_b64_tr_b16 a[16:17], v16 offset:0
    v_mfma_f32_16x16x32_bf16 v[224:227], a[112:115], v[168:171], v[224:227]
    ds_read_b64_tr_b16 a[18:19], v16 offset:1024
    v_mfma_f32_16x16x32_bf16 v[228:231], a[116:119], v[168:171], v[228:231]
    ds_read_b64_tr_b16 a[20:21], v17 offset:0
    v_mfma_f32_16x16x32_bf16 v[232:235], a[120:123], v[168:171], v[232:235]
    buffer_load_dwordx4 v[104:107], v40, s[64:67], s81 offen offset:2048 sc1
    v_mfma_f32_16x16x32_bf16 v[236:239], a[124:127], v[168:171], v[236:239]
    ds_read_b64_tr_b16 a[22:23], v17 offset:1024
    v_mfma_f32_16x16x32_bf16 v[252:255], a[124:127], v[172:175], v[252:255]
    ds_read_b64_tr_b16 a[24:25], v18 offset:0
    v_mfma_f32_16x16x32_bf16 v[248:251], a[120:123], v[172:175], v[248:251]
    buffer_load_dwordx4 v[108:111], v40, s[64:67], s81 offen offset:3072 sc1
    ds_read_b64_tr_b16 a[26:27], v18 offset:1024
    v_mfma_f32_16x16x32_bf16 v[244:247], a[116:119], v[172:175], v[244:247]
    ds_read_b64_tr_b16 a[28:29], v19 offset:0
    v_mfma_f32_16x16x32_bf16 v[240:243], a[112:115], v[172:175], v[240:243]
    ds_read_b64_tr_b16 a[30:31], v19 offset:1024
    s_waitcnt vmcnt(12) lgkmcnt(8)
    v_mfma_f32_16x16x32_bf16 v[192:195], a[0:3], v[144:147], v[192:195]
    v_mfma_f32_16x16x32_bf16 v[196:199], a[4:7], v[144:147], v[196:199]
    v_mfma_f32_16x16x32_bf16 v[200:203], a[8:11], v[144:147], v[200:203]
    s_waitcnt vmcnt(48)
    v_mfma_f32_16x16x32_bf16 v[204:207], a[12:15], v[144:147], v[204:207]
    s_mov_b32 s81, 4096
    buffer_load_dwordx4 v[176:179], v40, s[64:67], s81 offen offset:0 sc1
    v_mfma_f32_16x16x32_bf16 v[220:223], a[12:15], v[148:151], v[220:223]
    ds_read_b64_tr_b16 a[32:33], v16 offset:16384
    v_mfma_f32_16x16x32_bf16 v[216:219], a[8:11], v[148:151], v[216:219]
    ds_read_b64_tr_b16 a[34:35], v16 offset:17408
    v_mfma_f32_16x16x32_bf16 v[212:215], a[4:7], v[148:151], v[212:215]
    buffer_load_dwordx4 v[180:183], v40, s[64:67], s81 offen offset:1024 sc1
    v_mfma_f32_16x16x32_bf16 v[208:211], a[0:3], v[148:151], v[208:211]
    ds_read_b64_tr_b16 a[36:37], v17 offset:16384
    v_mfma_f32_16x16x32_bf16 v[224:227], a[0:3], v[152:155], v[224:227]
    v_mfma_f32_16x16x32_bf16 v[228:231], a[4:7], v[152:155], v[228:231]
    ds_read_b64_tr_b16 a[38:39], v17 offset:17408
    v_mfma_f32_16x16x32_bf16 v[232:235], a[8:11], v[152:155], v[232:235]
    buffer_load_dwordx4 v[184:187], v40, s[64:67], s81 offen offset:2048 sc1
    ds_read_b64_tr_b16 a[40:41], v18 offset:16384
    v_mfma_f32_16x16x32_bf16 v[236:239], a[12:15], v[152:155], v[236:239]
    v_mfma_f32_16x16x32_bf16 v[252:255], a[12:15], v[156:159], v[252:255]
    ds_read_b64_tr_b16 a[42:43], v18 offset:17408
    v_mfma_f32_16x16x32_bf16 v[248:251], a[8:11], v[156:159], v[248:251]
    buffer_load_dwordx4 v[188:191], v40, s[64:67], s81 offen offset:3072 sc1
    ds_read_b64_tr_b16 a[44:45], v19 offset:16384
    v_mfma_f32_16x16x32_bf16 v[244:247], a[4:7], v[156:159], v[244:247]
    v_mfma_f32_16x16x32_bf16 v[240:243], a[0:3], v[156:159], v[240:243]
    ds_read_b64_tr_b16 a[46:47], v19 offset:17408
    s_waitcnt vmcnt(12) lgkmcnt(8)
    v_mfma_f32_16x16x32_bf16 v[192:195], a[16:19], v[128:131], v[192:195]
    v_mfma_f32_16x16x32_bf16 v[196:199], a[20:23], v[128:131], v[196:199]
    v_mfma_f32_16x16x32_bf16 v[200:203], a[24:27], v[128:131], v[200:203]
    v_mfma_f32_16x16x32_bf16 v[204:207], a[28:31], v[128:131], v[204:207]
    s_mov_b32 s81, 8192
    buffer_load_dwordx4 v[160:163], v40, s[64:67], s81 offen offset:0 sc1
    v_mfma_f32_16x16x32_bf16 v[220:223], a[28:31], v[132:135], v[220:223]
    v_mfma_f32_16x16x32_bf16 v[216:219], a[24:27], v[132:135], v[216:219]
    v_mfma_f32_16x16x32_bf16 v[212:215], a[20:23], v[132:135], v[212:215]
    buffer_load_dwordx4 v[164:167], v40, s[64:67], s81 offen offset:1024 sc1
    v_mfma_f32_16x16x32_bf16 v[208:211], a[16:19], v[132:135], v[208:211]
    v_mfma_f32_16x16x32_bf16 v[224:227], a[16:19], v[136:139], v[224:227]
    v_mfma_f32_16x16x32_bf16 v[228:231], a[20:23], v[136:139], v[228:231]
    v_mfma_f32_16x16x32_bf16 v[232:235], a[24:27], v[136:139], v[232:235]
    buffer_load_dwordx4 v[168:171], v40, s[64:67], s81 offen offset:2048 sc1
    v_mfma_f32_16x16x32_bf16 v[236:239], a[28:31], v[136:139], v[236:239]
    v_mfma_f32_16x16x32_bf16 v[252:255], a[28:31], v[140:143], v[252:255]
    v_mfma_f32_16x16x32_bf16 v[248:251], a[24:27], v[140:143], v[248:251]
    buffer_load_dwordx4 v[172:175], v40, s[64:67], s81 offen offset:3072 sc1
    v_mfma_f32_16x16x32_bf16 v[244:247], a[20:23], v[140:143], v[244:247]
    v_mfma_f32_16x16x32_bf16 v[240:243], a[16:19], v[140:143], v[240:243]
    s_waitcnt vmcnt(12) lgkmcnt(0)
    v_mfma_f32_16x16x32_bf16 v[192:195], a[32:35], v[112:115], v[192:195]
    v_mfma_f32_16x16x32_bf16 v[196:199], a[36:39], v[112:115], v[196:199]
    v_mfma_f32_16x16x32_bf16 v[200:203], a[40:43], v[112:115], v[200:203]
    v_mfma_f32_16x16x32_bf16 v[204:207], a[44:47], v[112:115], v[204:207]
    s_mov_b32 s81, 12288
    buffer_load_dwordx4 v[144:147], v40, s[64:67], s81 offen offset:0 sc1
    v_mfma_f32_16x16x32_bf16 v[220:223], a[44:47], v[116:119], v[220:223]
    v_mfma_f32_16x16x32_bf16 v[216:219], a[40:43], v[116:119], v[216:219]
    v_mfma_f32_16x16x32_bf16 v[212:215], a[36:39], v[116:119], v[212:215]
    buffer_load_dwordx4 v[148:151], v40, s[64:67], s81 offen offset:1024 sc1
    v_mfma_f32_16x16x32_bf16 v[208:211], a[32:35], v[116:119], v[208:211]
    v_mfma_f32_16x16x32_bf16 v[224:227], a[32:35], v[120:123], v[224:227]
    v_mfma_f32_16x16x32_bf16 v[228:231], a[36:39], v[120:123], v[228:231]
    v_mfma_f32_16x16x32_bf16 v[232:235], a[40:43], v[120:123], v[232:235]
    buffer_load_dwordx4 v[152:155], v40, s[64:67], s81 offen offset:2048 sc1
    v_mfma_f32_16x16x32_bf16 v[236:239], a[44:47], v[120:123], v[236:239]
    v_mfma_f32_16x16x32_bf16 v[252:255], a[44:47], v[124:127], v[252:255]
    v_mfma_f32_16x16x32_bf16 v[248:251], a[40:43], v[124:127], v[248:251]
    buffer_load_dwordx4 v[156:159], v40, s[64:67], s81 offen offset:3072 sc1
    v_mfma_f32_16x16x32_bf16 v[244:247], a[36:39], v[124:127], v[244:247]
    v_mfma_f32_16x16x32_bf16 v[240:243], a[32:35], v[124:127], v[240:243]
    s_waitcnt vmcnt(12)
    v_mfma_f32_16x16x32_bf16 v[192:195], a[128:131], v[96:99], v[192:195]
    v_mfma_f32_16x16x32_bf16 v[196:199], a[132:135], v[96:99], v[196:199]
    v_mfma_f32_16x16x32_bf16 v[200:203], a[136:139], v[96:99], v[200:203]
    v_mfma_f32_16x16x32_bf16 v[204:207], a[140:143], v[96:99], v[204:207]
    buffer_load_dwordx4 a[48:51], v40, s[64:67], s12 offen offset:0 sc1
    v_mfma_f32_16x16x32_bf16 v[220:223], a[140:143], v[100:103], v[220:223]
    v_mfma_f32_16x16x32_bf16 v[216:219], a[136:139], v[100:103], v[216:219]
    v_mfma_f32_16x16x32_bf16 v[212:215], a[132:135], v[100:103], v[212:215]
    buffer_load_dwordx4 a[64:67], v40, s[64:67], s13 offen offset:0 sc1
    v_mfma_f32_16x16x32_bf16 v[208:211], a[128:131], v[100:103], v[208:211]
    v_mfma_f32_16x16x32_bf16 v[224:227], a[128:131], v[104:107], v[224:227]
    v_mfma_f32_16x16x32_bf16 v[228:231], a[132:135], v[104:107], v[228:231]
    v_mfma_f32_16x16x32_bf16 v[232:235], a[136:139], v[104:107], v[232:235]
    buffer_load_dwordx4 a[80:83], v40, s[64:67], s14 offen offset:0 sc1
    v_mfma_f32_16x16x32_bf16 v[236:239], a[140:143], v[104:107], v[236:239]
    v_mfma_f32_16x16x32_bf16 v[252:255], a[140:143], v[108:111], v[252:255]
    v_mfma_f32_16x16x32_bf16 v[248:251], a[136:139], v[108:111], v[248:251]
    buffer_load_dwordx4 a[96:99], v40, s[64:67], s15 offen offset:0 sc1
    v_mfma_f32_16x16x32_bf16 v[244:247], a[132:135], v[108:111], v[244:247]
    v_mfma_f32_16x16x32_bf16 v[240:243], a[128:131], v[108:111], v[240:243]
    s_waitcnt vmcnt(12)
    v_mfma_f32_16x16x32_bf16 v[192:195], a[144:147], v[176:179], v[192:195]
    v_mfma_f32_16x16x32_bf16 v[196:199], a[148:151], v[176:179], v[196:199]
    v_mfma_f32_16x16x32_bf16 v[200:203], a[152:155], v[176:179], v[200:203]
    v_mfma_f32_16x16x32_bf16 v[204:207], a[156:159], v[176:179], v[204:207]
    buffer_load_dwordx4 a[52:55], v40, s[64:67], s12 offen offset:1024 sc1
    v_mfma_f32_16x16x32_bf16 v[220:223], a[156:159], v[180:183], v[220:223]
    v_mfma_f32_16x16x32_bf16 v[216:219], a[152:155], v[180:183], v[216:219]
    v_mfma_f32_16x16x32_bf16 v[212:215], a[148:151], v[180:183], v[212:215]
    buffer_load_dwordx4 a[68:71], v40, s[64:67], s13 offen offset:1024 sc1
    v_mfma_f32_16x16x32_bf16 v[208:211], a[144:147], v[180:183], v[208:211]
    v_mfma_f32_16x16x32_bf16 v[224:227], a[144:147], v[184:187], v[224:227]
    v_mfma_f32_16x16x32_bf16 v[228:231], a[148:151], v[184:187], v[228:231]
    v_mfma_f32_16x16x32_bf16 v[232:235], a[152:155], v[184:187], v[232:235]
    buffer_load_dwordx4 a[84:87], v40, s[64:67], s14 offen offset:1024 sc1
    v_mfma_f32_16x16x32_bf16 v[236:239], a[156:159], v[184:187], v[236:239]
    v_mfma_f32_16x16x32_bf16 v[252:255], a[156:159], v[188:191], v[252:255]
    v_mfma_f32_16x16x32_bf16 v[248:251], a[152:155], v[188:191], v[248:251]
    buffer_load_dwordx4 a[100:103], v40, s[64:67], s15 offen offset:1024 sc1
    v_mfma_f32_16x16x32_bf16 v[244:247], a[148:151], v[188:191], v[244:247]
    v_mfma_f32_16x16x32_bf16 v[240:243], a[144:147], v[188:191], v[240:243]
    s_waitcnt vmcnt(12)
    v_mfma_f32_16x16x32_bf16 v[192:195], a[160:163], v[160:163], v[192:195]
    v_mfma_f32_16x16x32_bf16 v[196:199], a[164:167], v[160:163], v[196:199]
    v_mfma_f32_16x16x32_bf16 v[200:203], a[168:171], v[160:163], v[200:203]
    v_mfma_f32_16x16x32_bf16 v[204:207], a[172:175], v[160:163], v[204:207]
    buffer_load_dwordx4 a[56:59], v40, s[64:67], s12 offen offset:2048 sc1
    v_mfma_f32_16x16x32_bf16 v[220:223], a[172:175], v[164:167], v[220:223]
    v_mfma_f32_16x16x32_bf16 v[216:219], a[168:171], v[164:167], v[216:219]
    v_mfma_f32_16x16x32_bf16 v[212:215], a[164:167], v[164:167], v[212:215]
    buffer_load_dwordx4 a[72:75], v40, s[64:67], s13 offen offset:2048 sc1
    v_mfma_f32_16x16x32_bf16 v[208:211], a[160:163], v[164:167], v[208:211]
    v_mfma_f32_16x16x32_bf16 v[224:227], a[160:163], v[168:171], v[224:227]
    v_mfma_f32_16x16x32_bf16 v[228:231], a[164:167], v[168:171], v[228:231]
    v_mfma_f32_16x16x32_bf16 v[232:235], a[168:171], v[168:171], v[232:235]
    buffer_load_dwordx4 a[88:91], v40, s[64:67], s14 offen offset:2048 sc1
    v_mfma_f32_16x16x32_bf16 v[236:239], a[172:175], v[168:171], v[236:239]
    v_mfma_f32_16x16x32_bf16 v[252:255], a[172:175], v[172:175], v[252:255]
    v_mfma_f32_16x16x32_bf16 v[248:251], a[168:171], v[172:175], v[248:251]
    buffer_load_dwordx4 a[104:107], v40, s[64:67], s15 offen offset:2048 sc1
    v_mfma_f32_16x16x32_bf16 v[244:247], a[164:167], v[172:175], v[244:247]
    v_mfma_f32_16x16x32_bf16 v[240:243], a[160:163], v[172:175], v[240:243]
    s_waitcnt vmcnt(12)
    v_mfma_f32_16x16x32_bf16 v[192:195], a[176:179], v[144:147], v[192:195]
    v_mfma_f32_16x16x32_bf16 v[196:199], a[180:183], v[144:147], v[196:199]
    v_mfma_f32_16x16x32_bf16 v[200:203], a[184:187], v[144:147], v[200:203]
    v_mfma_f32_16x16x32_bf16 v[204:207], a[188:191], v[144:147], v[204:207]
    buffer_load_dwordx4 a[60:63], v40, s[64:67], s12 offen offset:3072 sc1
    v_mfma_f32_16x16x32_bf16 v[220:223], a[188:191], v[148:151], v[220:223]
    v_mfma_f32_16x16x32_bf16 v[216:219], a[184:187], v[148:151], v[216:219]
    v_mfma_f32_16x16x32_bf16 v[212:215], a[180:183], v[148:151], v[212:215]
    buffer_load_dwordx4 a[76:79], v40, s[64:67], s13 offen offset:3072 sc1
    v_mfma_f32_16x16x32_bf16 v[208:211], a[176:179], v[148:151], v[208:211]
    v_mfma_f32_16x16x32_bf16 v[224:227], a[176:179], v[152:155], v[224:227]
    v_mfma_f32_16x16x32_bf16 v[228:231], a[180:183], v[152:155], v[228:231]
    v_mfma_f32_16x16x32_bf16 v[232:235], a[184:187], v[152:155], v[232:235]
    buffer_load_dwordx4 a[92:95], v40, s[64:67], s14 offen offset:3072 sc1
    v_mfma_f32_16x16x32_bf16 v[236:239], a[188:191], v[152:155], v[236:239]
    v_mfma_f32_16x16x32_bf16 v[252:255], a[188:191], v[156:159], v[252:255]
    v_mfma_f32_16x16x32_bf16 v[248:251], a[184:187], v[156:159], v[248:251]
    buffer_load_dwordx4 a[108:111], v40, s[64:67], s15 offen offset:3072 sc1
    v_mfma_f32_16x16x32_bf16 v[244:247], a[180:183], v[156:159], v[244:247]
    v_mfma_f32_16x16x32_bf16 v[240:243], a[176:179], v[156:159], v[240:243]
    s_waitcnt vmcnt(12)
    v_mfma_f32_16x16x32_bf16 v[192:195], a[192:195], a[48:51], v[192:195]
    v_mfma_f32_16x16x32_bf16 v[196:199], a[196:199], a[48:51], v[196:199]
    v_mfma_f32_16x16x32_bf16 v[200:203], a[200:203], a[48:51], v[200:203]
    v_mfma_f32_16x16x32_bf16 v[204:207], a[204:207], a[48:51], v[204:207]
    v_mfma_f32_16x16x32_bf16 v[192:195], a[208:211], a[64:67], v[192:195]
    v_mfma_f32_16x16x32_bf16 v[196:199], a[212:215], a[64:67], v[196:199]
    v_mfma_f32_16x16x32_bf16 v[200:203], a[216:219], a[64:67], v[200:203]
    v_mfma_f32_16x16x32_bf16 v[204:207], a[220:223], a[64:67], v[204:207]
    v_mfma_f32_16x16x32_bf16 v[192:195], a[224:227], a[80:83], v[192:195]
    v_mfma_f32_16x16x32_bf16 v[196:199], a[228:231], a[80:83], v[196:199]
    v_mfma_f32_16x16x32_bf16 v[200:203], a[232:235], a[80:83], v[200:203]
    v_mfma_f32_16x16x32_bf16 v[204:207], a[236:239], a[80:83], v[204:207]
    v_mfma_f32_16x16x32_bf16 v[192:195], a[240:243], a[96:99], v[192:195]
    v_mfma_f32_16x16x32_bf16 v[196:199], a[244:247], a[96:99], v[196:199]
    v_mfma_f32_16x16x32_bf16 v[200:203], a[248:251], a[96:99], v[200:203]
    v_mfma_f32_16x16x32_bf16 v[204:207], a[252:255], a[96:99], v[204:207]
    s_waitcnt vmcnt(8)
    v_mfma_f32_16x16x32_bf16 v[208:211], a[192:195], a[52:55], v[208:211]
    v_mfma_f32_16x16x32_bf16 v[212:215], a[196:199], a[52:55], v[212:215]
    v_mfma_f32_16x16x32_bf16 v[216:219], a[200:203], a[52:55], v[216:219]
    v_mfma_f32_16x16x32_bf16 v[220:223], a[204:207], a[52:55], v[220:223]
    v_mfma_f32_16x16x32_bf16 v[208:211], a[208:211], a[68:71], v[208:211]
    v_mfma_f32_16x16x32_bf16 v[212:215], a[212:215], a[68:71], v[212:215]
    v_mfma_f32_16x16x32_bf16 v[216:219], a[216:219], a[68:71], v[216:219]
    ds_write_b128 v42, v[192:195] offset:0
    v_mfma_f32_16x16x32_bf16 v[220:223], a[220:223], a[68:71], v[220:223]
    v_mfma_f32_16x16x32_bf16 v[208:211], a[224:227], a[84:87], v[208:211]
    ds_write_b128 v43, v[196:199] offset:0
    v_mfma_f32_16x16x32_bf16 v[212:215], a[228:231], a[84:87], v[212:215]
    v_mfma_f32_16x16x32_bf16 v[216:219], a[232:235], a[84:87], v[216:219]
    ds_write_b128 v44, v[200:203] offset:0
    v_mfma_f32_16x16x32_bf16 v[220:223], a[236:239], a[84:87], v[220:223]
    v_mfma_f32_16x16x32_bf16 v[208:211], a[240:243], a[100:103], v[208:211]
    ds_write_b128 v45, v[204:207] offset:0
    v_mfma_f32_16x16x32_bf16 v[212:215], a[244:247], a[100:103], v[212:215]
    v_mfma_f32_16x16x32_bf16 v[216:219], a[248:251], a[100:103], v[216:219]
    v_mfma_f32_16x16x32_bf16 v[220:223], a[252:255], a[100:103], v[220:223]
    s_waitcnt vmcnt(4) lgkmcnt(0)
    s_barrier
    v_mfma_f32_16x16x32_bf16 v[224:227], a[192:195], a[56:59], v[224:227]
    ds_read_b128 v[176:179], v46 offset:0
    v_mfma_f32_16x16x32_bf16 v[228:231], a[196:199], a[56:59], v[228:231]
    ds_read_b128 v[180:183], v46 offset:4096
    v_mfma_f32_16x16x32_bf16 v[232:235], a[200:203], a[56:59], v[232:235]
    ds_read_b128 v[184:187], v46 offset:8192
    v_mfma_f32_16x16x32_bf16 v[236:239], a[204:207], a[56:59], v[236:239]
    ds_read_b128 v[188:191], v46 offset:12288
    v_mfma_f32_16x16x32_bf16 v[224:227], a[208:211], a[72:75], v[224:227]
    v_mfma_f32_16x16x32_bf16 v[228:231], a[212:215], a[72:75], v[228:231]
    ds_write_b128 v42, v[208:211] offset:16384
    v_mfma_f32_16x16x32_bf16 v[232:235], a[216:219], a[72:75], v[232:235]
    ds_write_b128 v43, v[212:215] offset:16384
    v_mfma_f32_16x16x32_bf16 v[236:239], a[220:223], a[72:75], v[236:239]
    ds_write_b128 v44, v[216:219] offset:16384
    s_mov_b32 s81, 0
    v_mfma_f32_16x16x32_bf16 v[224:227], a[224:227], a[88:91], v[224:227]
    ds_write_b128 v45, v[220:223] offset:16384
    s_waitcnt lgkmcnt(4)
    v_add_f32 v60, v60, v176
    v_mfma_f32_16x16x32_bf16 v[228:231], a[228:231], a[88:91], v[228:231]
    v_add_f32 v61, v61, v177
    v_add_f32 v62, v62, v178
    v_mfma_f32_16x16x32_bf16 v[232:235], a[232:235], a[88:91], v[232:235]
    v_add_f32 v63, v63, v179
    v_add_f32 v60, v60, v180
    v_add_f32 v61, v61, v181
    v_mfma_f32_16x16x32_bf16 v[236:239], a[236:239], a[88:91], v[236:239]
    v_add_f32 v62, v62, v182
    v_add_f32 v63, v63, v183
    v_mfma_f32_16x16x32_bf16 v[224:227], a[240:243], a[104:107], v[224:227]
    v_add_f32 v60, v60, v184
    v_add_f32 v61, v61, v185
    v_add_f32 v62, v62, v186
    v_mfma_f32_16x16x32_bf16 v[228:231], a[244:247], a[104:107], v[228:231]
    v_add_f32 v63, v63, v187
    v_add_f32 v60, v60, v188
    v_mfma_f32_16x16x32_bf16 v[232:235], a[248:251], a[104:107], v[232:235]
    v_add_f32 v61, v61, v189
    v_add_f32 v62, v62, v190
    v_mfma_f32_16x16x32_bf16 v[236:239], a[252:255], a[104:107], v[236:239]
    v_add_f32 v63, v63, v191
    buffer_store_dwordx4 v[60:63], v9, s[68:71], s81 offen sc1
    s_waitcnt vmcnt(1) lgkmcnt(0)
    s_barrier
    v_mfma_f32_16x16x32_bf16 v[240:243], a[192:195], a[60:63], v[240:243]
    ds_read_b128 v[160:163], v46 offset:16384
    v_mfma_f32_16x16x32_bf16 v[244:247], a[196:199], a[60:63], v[244:247]
    ds_read_b128 v[164:167], v46 offset:20480
    v_mfma_f32_16x16x32_bf16 v[248:251], a[200:203], a[60:63], v[248:251]
    ds_read_b128 v[168:171], v46 offset:24576
    v_mfma_f32_16x16x32_bf16 v[252:255], a[204:207], a[60:63], v[252:255]
    ds_read_b128 v[172:175], v46 offset:28672
    v_mfma_f32_16x16x32_bf16 v[240:243], a[208:211], a[76:79], v[240:243]
    v_mfma_f32_16x16x32_bf16 v[244:247], a[212:215], a[76:79], v[244:247]
    ds_write_b128 v42, v[224:227] offset:32768
    v_mfma_f32_16x16x32_bf16 v[248:251], a[216:219], a[76:79], v[248:251]
    ds_write_b128 v43, v[228:231] offset:32768
    v_mfma_f32_16x16x32_bf16 v[252:255], a[220:223], a[76:79], v[252:255]
    ds_write_b128 v44, v[232:235] offset:32768
    s_mov_b32 s81, 16384
    v_mfma_f32_16x16x32_bf16 v[240:243], a[224:227], a[92:95], v[240:243]
    ds_write_b128 v45, v[236:239] offset:32768
    s_waitcnt lgkmcnt(4)
    v_add_f32 v64, v64, v160
    v_mfma_f32_16x16x32_bf16 v[244:247], a[228:231], a[92:95], v[244:247]
    v_add_f32 v65, v65, v161
    v_add_f32 v66, v66, v162
    v_mfma_f32_16x16x32_bf16 v[248:251], a[232:235], a[92:95], v[248:251]
    v_add_f32 v67, v67, v163
    v_add_f32 v64, v64, v164
    v_add_f32 v65, v65, v165
    v_mfma_f32_16x16x32_bf16 v[252:255], a[236:239], a[92:95], v[252:255]
    v_add_f32 v66, v66, v166
    v_add_f32 v67, v67, v167
    v_mfma_f32_16x16x32_bf16 v[240:243], a[240:243], a[108:111], v[240:243]
    v_add_f32 v64, v64, v168
    v_add_f32 v65, v65, v169
    v_add_f32 v66, v66, v170
    v_mfma_f32_16x16x32_bf16 v[244:247], a[244:247], a[108:111], v[244:247]
    v_add_f32 v67, v67, v171
    v_add_f32 v64, v64, v172
    v_mfma_f32_16x16x32_bf16 v[248:251], a[248:251], a[108:111], v[248:251]
    v_add_f32 v65, v65, v173
    v_add_f32 v66, v66, v174
    v_mfma_f32_16x16x32_bf16 v[252:255], a[252:255], a[108:111], v[252:255]
    v_add_f32 v67, v67, v175
    buffer_store_dwordx4 v[64:67], v9, s[68:71], s81 offen sc1
    s_waitcnt lgkmcnt(0)
    s_barrier
    ds_read_b128 v[144:147], v46 offset:32768
    ds_read_b128 v[148:151], v46 offset:36864
    ds_read_b128 v[152:155], v46 offset:40960
    ds_read_b128 v[156:159], v46 offset:45056
    ds_write_b128 v42, v[240:243] offset:49152
    ds_write_b128 v43, v[244:247] offset:49152
    ds_write_b128 v44, v[248:251] offset:49152
    ds_write_b128 v45, v[252:255] offset:49152
    s_mov_b32 s81, 65536
    s_waitcnt lgkmcnt(4)
    v_pk_add_f32 v[144:145], v[144:145], v[148:149]
    v_pk_add_f32 v[152:153], v[152:153], v[156:157]
    v_pk_add_f32 v[68:69], v[68:69], v[144:145]
    v_pk_add_f32 v[68:69], v[68:69], v[152:153]
    v_pk_add_f32 v[146:147], v[146:147], v[150:151]
    v_pk_add_f32 v[154:155], v[154:155], v[158:159]
    v_pk_add_f32 v[70:71], v[70:71], v[146:147]
    v_pk_add_f32 v[70:71], v[70:71], v[154:155]
    buffer_store_dwordx4 v[68:71], v9, s[68:71], s81 offen sc1
    s_waitcnt lgkmcnt(0)
    s_barrier
    ds_read_b128 v[128:131], v46 offset:49152
    ds_read_b128 v[132:135], v46 offset:53248
    ds_read_b128 v[136:139], v46 offset:57344
    ds_read_b128 v[140:143], v46 offset:61440
    s_mov_b32 s81, 81920
    s_waitcnt lgkmcnt(0)
    v_pk_add_f32 v[128:129], v[128:129], v[132:133]
    v_pk_add_f32 v[136:137], v[136:137], v[140:141]
    v_pk_add_f32 v[72:73], v[72:73], v[128:129]
    v_pk_add_f32 v[72:73], v[72:73], v[136:137]
    v_pk_add_f32 v[130:131], v[130:131], v[134:135]
    v_pk_add_f32 v[138:139], v[138:139], v[142:143]
    v_pk_add_f32 v[74:75], v[74:75], v[130:131]
    v_pk_add_f32 v[74:75], v[74:75], v[138:139]
    buffer_store_dwordx4 v[72:75], v9, s[68:71], s81 offen sc1
    s_cmp_lg_u32 s2, 255
    s_cbranch_scc1 L_fin
    s_cmp_lg_u32 s3, 0
    s_cbranch_scc1 L_fin
    s_mov_b64 exec, 1
    v_mov_b32 v1, 0
    buffer_store_dword v87, v1, s[64:67], 0 offen sc1
L_fin:
L_end:
    s_endpgm
L_slow_st:
    s_mov_b32 s85, 0x20000
L_slow_st2:
    buffer_load_dwordx2 v[74:75], v50, s[64:67], 0 offen sc1
    s_sub_u32 s85, s85, 1
    s_cmp_eq_u32 s85, 0
    s_waitcnt vmcnt(0)
    s_cbranch_scc1 L_back_st
    v_cmp_ne_u32 vcc, s72, v75
    s_cbranch_vccnz L_slow_st2
    s_branch L_back_st
L_slow_cg:
    s_mov_b32 s85, 0x20000
L_slow_cg2:
    buffer_load_dwordx4 v[164:167], v91, s[64:67], 0 offen sc1
    buffer_load_dwordx4 v[168:171], v92, s[64:67], 0 offen offset:512 sc1
    s_sub_u32 s85, s85, 1
    s_cmp_eq_u32 s85, 0
    s_waitcnt vmcnt(0)
    s_cbranch_scc1 L_back_cg
    v_cmp_ne_u32 s[6:7], s72, v165
    v_cmp_ne_u32 s[8:9], s72, v167
    v_cmp_ne_u32 s[10:11], s72, v169
    v_cmp_ne_u32 s[12:13], s72, v171
    s_or_b64 s[6:7], s[6:7], s[8:9]
    s_and_b64 s[6:7], s[6:7], s[90:91]
    s_or_b64 s[10:11], s[10:11], s[12:13]
    s_and_b64 s[10:11], s[10:11], s[92:93]
    s_or_b64 s[6:7], s[6:7], s[10:11]
    s_cbranch_scc1 L_slow_cg2
    s_branch L_back_cg
L_slow_m:
    s_sub_u32 s85, s85, 1
    s_cmp_eq_u32 s85, 0
    s_cbranch_scc1 L_back_m
    s_load_dword s4, s[88:89], 0 glc
    s_load_dword s5, s[88:89], 128 glc
    s_load_dword s6, s[88:89], 256 glc
    s_load_dword s7, s[88:89], 384 glc
    s_load_dword s8, s[88:89], 512 glc
    s_branch L_chk_m
L_code_end:
.section .rodata,"a"
.p2align 6
.amdhsa_kernel parallel_sum__ssm_conv_s5__dense_activation_squared_relu__prompt_kernel
  .amdhsa_next_free_vgpr 512
  .amdhsa_next_free_sgpr 102
  .amdhsa_accum_offset 256
  .amdhsa_group_segment_fixed_size 0
  .amdhsa_kernarg_size 136
  .amdhsa_user_sgpr_count 2
  .amdhsa_user_sgpr_kernarg_segment_ptr 1
  .amdhsa_system_sgpr_workgroup_id_x 1
  .amdhsa_float_denorm_mode_32 3
.end_amdhsa_kernel
```
